```python
import torch

def _softmax(x, axis=-1):
    return torch.softmax(x, dim=axis)
def _gelu(x):
    return torch.nn.functional.gelu(x, approximate="tanh")
def _silu(x):
    return torch.nn.functional.silu(x)
def _sigmoid(x):
    return torch.sigmoid(x)
def _layernorm(x, axis=-1, eps=1e-5):
    m = x.mean(dim=axis, keepdim=True)
    v = x.var(dim=axis, keepdim=True, unbiased=False)
    return (x - m) / torch.sqrt(v + eps)
def _scatter_add(tgt, idx, src, axis=0):
    return tgt.clone().index_add_(axis, idx, src)
def _segment_sum(src, seg, n):
    out = torch.zeros((n,) + src.shape[1:], dtype=src.dtype)
    return out.index_add_(0, seg, src)
def _pad(x, pw):
    flat = tuple(v for pair in reversed(pw) for v in pair)
    return torch.nn.functional.pad(x, flat)

kernel_name = 'recurrent_scan__sliding_block__geglu_ffn__prompt'

def setup_inputs():

    _w = (lambda a: (lambda t: t.to(torch.bfloat16) if t.is_floating_point() else t)(torch.as_tensor(a)))
    def _A_setup():
        B, S, D = 1, 2048, 448
        return {
            "x": _w((lambda *s: torch.randn(*s, dtype=torch.bfloat16) * 0.05)(B, S, D)),
            "wqkv": _w((lambda *s: torch.randn(*s, dtype=torch.bfloat16) * 0.05)(D, 3 * D)),
            "wo": _w((lambda *s: torch.randn(*s, dtype=torch.bfloat16) * 0.05)(D, D)),
        }
    _A_in = _A_setup()

    def _B_setup():
        B, S, D, F = 1, 2048, 448, 1792
        return {
            "x": _w((lambda *s: torch.randn(*s, dtype=torch.bfloat16) * 0.05)(B, S, D)),
            "w_gate": _w((lambda *s: torch.randn(*s, dtype=torch.bfloat16) * 0.05)(D, F)),
            "w_up": _w((lambda *s: torch.randn(*s, dtype=torch.bfloat16) * 0.05)(D, F)),
            "w_down": _w((lambda *s: torch.randn(*s, dtype=torch.bfloat16) * 0.05)(F, D)),
        }
    _B_in = _B_setup()

    return {
        "A_x": _A_in["x"],
        "A_wqkv": _A_in["wqkv"],
        "A_wo": _A_in["wo"],
        "B_x": _B_in["x"],
        "B_w_gate": _B_in["w_gate"],
        "B_w_up": _B_in["w_up"],
        "B_w_down": _B_in["w_down"],
    }

def reference(A_x, A_wqkv, A_wo, B_x, B_w_gate, B_w_up, B_w_down):
    def _A_ref(x, wqkv, wo):
        B, S, D = x.shape
        H = 16; Dh = D // H; W = 256
        qkv = (lambda x, *d: x.permute(*d))((x @ wqkv).reshape(B, S, 3, H, Dh), 2, 0, 3, 1, 4)
        q, k, v = qkv[0], qkv[1], qkv[2]
        scores = torch.einsum("bhqd,bhkd->bhqk", q, k) * (Dh ** -0.5)
        idx = torch.arange(S)
        mask = (idx[:, None] - idx[None, :] >= 0) & (idx[:, None] - idx[None, :] < W)
        scores = torch.where(mask[None, None], scores, -1e9)
        p = _softmax(scores, axis=-1)
        o = torch.einsum("bhqk,bhkd->bhqd", p, v)
        return (lambda x, *d: x.permute(*d))(o, 0, 2, 1, 3).reshape(B, S, D) @ wo

    def _B_ref(x, w_gate, w_up, w_down):
        return (_gelu(x @ w_gate) * (x @ w_up)) @ w_down

    x = A_x
    xn = _layernorm(x, axis=-1)
    s = _A_ref(xn, A_wqkv, A_wo)
    g = _silu(_B_ref(xn, B_w_gate, B_w_up, B_w_down))
    return x + s * g
```

```asm
; @launch grid=(256,1,1) block=(512,1,1) lds=163840
.amdgcn_target "amdgcn-amd-amdhsa--gfx950"
.text
.globl recurrent_scan__sliding_block__geglu_ffn__prompt_kernel
.p2align 8
.type recurrent_scan__sliding_block__geglu_ffn__prompt_kernel,@function
recurrent_scan__sliding_block__geglu_ffn__prompt_kernel:
    s_cmp_ge_u32 s2, 256
    s_cbranch_scc1 L_end
    s_load_dwordx2 s[8:9], s[0:1], 0
    s_load_dwordx2 s[12:13], s[0:1], 8
    s_load_dwordx2 s[16:17], s[0:1], 32
    s_load_dwordx2 s[20:21], s[0:1], 40
    s_load_dwordx2 s[36:37], s[0:1], 72
    s_load_dwordx2 s[24:25], s[0:1], 48
    s_load_dwordx2 s[28:29], s[0:1], 16
    s_load_dwordx2 s[32:33], s[0:1], 56
    v_lshrrev_b32 v2, 6, v0
    v_and_b32 v1, 63, v0
    v_readfirstlane_b32 s5, v2
    s_and_b32 s3, s2, 1
    s_lshl_b32 s3, s3, 3
    s_bfe_u32 s82, s2, 0x30003
    s_add_u32 s3, s3, s82
    s_bfe_u32 s83, s2, 0x10002
    s_mul_i32 s84, s83, 7
    s_add_u32 s83, s83, 14
    s_and_b32 s4, s2, 2
    s_lshl_b32 s4, s4, 1
    s_add_u32 s4, s4, s84
    s_add_u32 s84, s84, 3
    s_lshr_b32 s85, s2, 4
    s_xor_b32 s85, s85, s2
    s_bitcmp1_b32 s85, 1
    s_cselect_b32 s84, s83, s84
    s_lshr_b32 s82, s2, 6
    s_xor_b32 s82, s82, 3
    s_add_u32 s4, s4, s82
    s_cmp_eq_u32 s82, 3
    s_cselect_b32 s4, s84, s4
    s_lshl_b32 s66, s5, 10
    s_and_b32 s70, s3, 3
    s_lshr_b32 s82, s3, 3
    s_lshl_b32 s82, s82, 2
    s_add_u32 s70, s70, s82
    s_cmp_eq_u32 s70, 7
    s_cselect_b32 s70, 5, s70
    v_lshrrev_b32 v124, 3, v1
    v_and_b32 v125, 7, v1
    v_lshrrev_b32 v126, 4, v1
    s_lshl_b32 s82, s5, 3
    v_add_u32 v127, s82, v124
    s_lshl_b32 s83, s3, 7
    v_add_u32 v128, s83, v127
    s_and_b32 s84, s5, 1
    s_lshl_b32 s84, s84, 2
    v_xor_b32 v129, v125, v126
    v_xor_b32 v129, s84, v129
    v_lshlrev_b32 v129, 4, v129
    s_movk_i32 s85, 896
    v_mad_u32_u24 v2, v128, s85, v129
    s_mov_b32 s10, 1835008
    s_mov_b32 s11, 0x00020000
    s_mov_b32 s14, 1204224
    s_mov_b32 s15, 0x00020000
    s_mov_b32 s18, 1605632
    s_mov_b32 s19, 0x00020000
    s_mov_b32 s22, 1605632
    s_mov_b32 s23, 0x00020000
    s_cmp_ge_u32 s4, 14
    s_cbranch_scc1 L_light
    v_and_b32 v130, 1, v126
    v_lshlrev_b32 v131, 2, v130
    v_xor_b32 v131, v131, v125
    v_lshlrev_b32 v131, 4, v131
    s_movk_i32 s82, 2688
    v_mad_u32_u24 v3, v127, s82, v131
    s_lshl_b32 s83, s4, 7
    v_add_u32 v3, s83, v3
    v_lshlrev_b32 v131, 1, v130
    v_xor_b32 v131, v131, v125
    v_lshlrev_b32 v131, 4, v131
    s_movk_i32 s82, 3584
    v_mad_u32_u24 v4, v127, s82, v131
    s_lshl_b32 s83, s4, 8
    v_add_u32 v4, s83, v4
    v_xor_b32 v5, 64, v4
    s_waitcnt lgkmcnt(0)
    s_add_u32 m0, s66, 0
    s_lshl_b32 s82, s70, 7
    buffer_load_dwordx4 v2, s[8:11], s82 offen lds
    s_add_u32 m0, s66, 8192
    s_lshl_b32 s82, s70, 7
    s_add_u32 s82, s82, 57344
    buffer_load_dwordx4 v2, s[8:11], s82 offen lds
    s_add_u32 m0, s66, 98304
    s_mul_i32 s82, s70, 172032
    buffer_load_dwordx4 v3, s[12:15], s82 offen lds
    s_add_u32 m0, s66, 49152
    s_mul_i32 s83, s70, 229376
    buffer_load_dwordx4 v4, s[16:19], s83 offen lds
    s_add_u32 m0, s66, 57344
    s_mul_i32 s83, s70, 229376
    buffer_load_dwordx4 v5, s[20:23], s83 offen lds
    s_barrier
    s_load_dword s64, s[36:37], 0
    s_lshl_b32 s83, s3, 7
    s_lshl_b32 s82, s4, 3
    s_add_u32 s82, s82, s83
    s_add_u32 s82, s82, s5
    s_mul_i32 s86, s82, 896
    s_lshl_b32 s68, s82, 4
    s_add_u32 s68, s68, 131072
    v_lshlrev_b32 v130, 4, v1
    v_cmp_gt_u32 vcc, 56, v1
    v_mov_b32 v131, 0x7ffffff0
    s_and_b32 s6, s5, 3
    s_lshr_b32 s7, s5, 2
    v_cndmask_b32 v130, v131, v130, vcc
    buffer_load_dwordx4 v[136:139], v130, s[8:11], s86 offen
    s_mov_b32 s65, 0x3f803f80
    s_mov_b32 s100, 0
    s_lshl_b32 s67, s7, 1
    s_xor_b32 s67, s67, s6
    s_mov_b32 s40, s70
    s_add_u32 s71, s70, 1
    s_cmp_eq_u32 s71, 7
    s_cselect_b32 s71, 0, s71
    s_add_u32 s72, s71, 1
    s_cmp_eq_u32 s72, 7
    s_cselect_b32 s72, 0, s72
    s_add_u32 s73, s72, 1
    s_cmp_eq_u32 s73, 7
    s_cselect_b32 s73, 0, s73
    s_add_u32 s74, s73, 1
    s_cmp_eq_u32 s74, 7
    s_cselect_b32 s74, 0, s74
    s_add_u32 s75, s74, 1
    s_cmp_eq_u32 s75, 7
    s_cselect_b32 s75, 0, s75
    s_add_u32 s76, s75, 1
    s_cmp_eq_u32 s76, 7
    s_cselect_b32 s76, 0, s76
    s_mov_b32 s26, 1605632
    s_mov_b32 s27, 0x00020000
    s_mov_b32 s30, 401408
    s_mov_b32 s31, 0x00020000
    s_mov_b32 s34, 1835008
    s_mov_b32 s35, 0x00020000
    s_mov_b32 s38, 35651584
    s_mov_b32 s39, 0x00020000
    s_getpc_b64 s[86:87]
pc_1:
    s_add_u32 s86, s86, recurrent_scan__sliding_block__geglu_ffn__prompt_kernel-pc_1
    s_addc_u32 s87, s87, -1
    s_and_b32 s88, s2, 0x38
    s_lshl_b32 s88, s88, 10
    s_add_u32 s88, s88, s66
    s_min_u32 s88, s88, L_codeend-recurrent_scan__sliding_block__geglu_ffn__prompt_kernel-1024
    v_lshlrev_b32 v130, 4, v1
    v_add_u32 v130, s88, v130
    global_load_dwordx4 v[140:143], v130, s[86:87]
    s_add_u32 m0, s66, 16384
    s_lshl_b32 s82, s71, 7
    buffer_load_dwordx4 v2, s[8:11], s82 offen lds
    s_add_u32 m0, s66, 24576
    s_lshl_b32 s82, s71, 7
    s_add_u32 s82, s82, 57344
    buffer_load_dwordx4 v2, s[8:11], s82 offen lds
    s_add_u32 m0, s66, 106496
    s_mul_i32 s82, s71, 172032
    buffer_load_dwordx4 v3, s[12:15], s82 offen lds
    s_add_u32 m0, s66, 65536
    s_mul_i32 s83, s71, 229376
    buffer_load_dwordx4 v4, s[16:19], s83 offen lds
    s_add_u32 m0, s66, 73728
    s_mul_i32 s83, s71, 229376
    buffer_load_dwordx4 v5, s[20:23], s83 offen lds
    v_and_b32 v130, 31, v1
    v_lshrrev_b32 v131, 5, v1
    v_bfe_u32 v132, v1, 1, 3
    v_xor_b32 v132, v132, v131
    s_lshl_b32 s82, s6, 12
    v_lshlrev_b32 v130, 7, v130
    v_add_u32 v130, s82, v130
    v_lshl_add_u32 v6, v132, 4, v130
    s_lshl_b32 s82, s67, 5
    v_xor_b32 v6, s82, v6
    v_xor_b32 v7, 32, v6
    v_xor_b32 v8, 64, v6
    v_xor_b32 v9, 96, v6
    v_bfe_u32 v130, v1, 2, 2
    v_lshrrev_b32 v131, 5, v1
    v_lshl_add_u32 v131, v131, 3, v130
    v_lshlrev_b32 v131, 7, v131
    v_and_b32 v132, 3, v1
    v_lshl_add_u32 v131, v132, 3, v131
    v_bfe_u32 v132, v1, 3, 1
    v_bfe_u32 v133, v1, 4, 1
    v_xor_b32 v134, s7, v132
    v_lshl_add_u32 v10, v134, 6, v131
    v_lshl_add_u32 v10, v133, 5, v10
    s_lshl_b32 s82, s7, 1
    v_lshlrev_b32 v134, 1, v133
    v_xor_b32 v134, v134, v132
    v_xor_b32 v134, s82, v134
    v_lshl_add_u32 v11, v134, 5, v131
    v_lshl_add_u32 v11, v133, 13, v11
    s_lshl_b32 s82, s67, 11
    v_xor_b32 v10, s82, v10
    v_xor_b32 v11, s82, v11
    v_xor_b32 v12, 32, v11
    s_waitcnt lgkmcnt(0)
    s_add_u32 s64, s64, 0x3c6ef35f
    v_add_u32 v10, 0x18000, v10
    v_add_u32 v11, 0xc000, v11
    v_add_u32 v12, 0xc000, v12
    s_waitcnt vmcnt(7)
    s_barrier
    ds_read_b64_tr_b16 v[20:21], v10 offset:0
    ds_read_b64_tr_b16 v[22:23], v10 offset:512
    ds_read_b128 v[144:147], v6 offset:0
    ds_read_b64_tr_b16 v[24:25], v11 offset:0
    ds_read_b64_tr_b16 v[26:27], v11 offset:512
    ds_read_b64_tr_b16 v[28:29], v12 offset:0
    ds_read_b64_tr_b16 v[30:31], v12 offset:512
    v_xor_b32 v10, 2048, v10
    ds_read_b64_tr_b16 v[32:33], v10 offset:0
    ds_read_b64_tr_b16 v[34:35], v10 offset:512
    ds_read_b128 v[148:151], v7 offset:0
    v_xor_b32 v11, 2048, v11
    ds_read_b64_tr_b16 v[36:37], v11 offset:0
    ds_read_b64_tr_b16 v[38:39], v11 offset:512
    v_xor_b32 v12, 2048, v12
    ds_read_b64_tr_b16 v[40:41], v12 offset:0
    ds_read_b64_tr_b16 v[42:43], v12 offset:512
    s_waitcnt lgkmcnt(7)
    v_mfma_f32_32x32x16_bf16 v[44:59], v[20:23], v[144:147], 0
    s_add_u32 m0, s66, 32768
    s_lshl_b32 s82, s72, 7
    buffer_load_dwordx4 v2, s[8:11], s82 offen lds
    v_xor_b32 v10, 6144, v10
    ds_read_b64_tr_b16 v[92:93], v10 offset:0
    ds_read_b64_tr_b16 v[94:95], v10 offset:512
    ds_read_b128 v[152:155], v8 offset:0
    v_mfma_f32_32x32x16_bf16 v[60:75], v[24:27], v[144:147], 0
    s_add_u32 m0, s66, 40960
    s_lshl_b32 s82, s72, 7
    s_add_u32 s82, s82, 57344
    buffer_load_dwordx4 v2, s[8:11], s82 offen lds
    v_xor_b32 v11, 6144, v11
    ds_read_b64_tr_b16 v[96:97], v11 offset:0
    ds_read_b64_tr_b16 v[98:99], v11 offset:512
    v_mfma_f32_32x32x16_bf16 v[76:91], v[28:31], v[144:147], 0
    s_waitcnt vmcnt(8)
    v_lshlrev_b32 v124, 16, v136
    v_and_b32 v125, 0xffff0000, v136
    v_lshlrev_b32 v126, 16, v137
    s_add_u32 m0, s66, 114688
    s_mul_i32 s82, s72, 172032
    buffer_load_dwordx4 v3, s[12:15], s82 offen lds
    v_xor_b32 v12, 6144, v12
    ds_read_b64_tr_b16 v[100:101], v12 offset:0
    ds_read_b64_tr_b16 v[102:103], v12 offset:512
    v_mov_b32 v13, 0
    v_mov_b32 v14, 0
    v_mov_b32 v15, 0
    v_dot2c_f32_bf16 v13, s65, v20
    v_dot2c_f32_bf16 v14, s65, v24
    v_dot2c_f32_bf16 v15, s65, v28
    v_dot2c_f32_bf16 v13, s65, v21
    v_dot2c_f32_bf16 v14, s65, v25
    v_dot2c_f32_bf16 v15, s65, v29
    v_dot2c_f32_bf16 v13, s65, v22
    v_dot2c_f32_bf16 v14, s65, v26
    v_dot2c_f32_bf16 v15, s65, v30
    v_dot2c_f32_bf16 v13, s65, v23
    v_dot2c_f32_bf16 v14, s65, v27
    v_dot2c_f32_bf16 v15, s65, v31
    s_waitcnt lgkmcnt(7)
    v_mfma_f32_32x32x16_bf16 v[44:59], v[32:35], v[148:151], v[44:59]
    v_and_b32 v127, 0xffff0000, v137
    v_lshlrev_b32 v128, 16, v138
    s_add_u32 m0, s66, 81920
    s_mul_i32 s83, s72, 229376
    buffer_load_dwordx4 v4, s[16:19], s83 offen lds
    v_xor_b32 v10, 2048, v10
    ds_read_b64_tr_b16 v[20:21], v10 offset:0
    ds_read_b64_tr_b16 v[22:23], v10 offset:512
    ds_read_b128 v[156:159], v9 offset:0
    v_xor_b32 v11, 2048, v11
    ds_read_b64_tr_b16 v[24:25], v11 offset:0
    ds_read_b64_tr_b16 v[26:27], v11 offset:512
    v_xor_b32 v12, 2048, v12
    ds_read_b64_tr_b16 v[28:29], v12 offset:0
    ds_read_b64_tr_b16 v[30:31], v12 offset:512
    v_mfma_f32_32x32x16_bf16 v[60:75], v[36:39], v[148:151], v[60:75]
    v_and_b32 v129, 0xffff0000, v138
    v_lshlrev_b32 v130, 16, v139
    s_add_u32 m0, s66, 90112
    s_mul_i32 s83, s72, 229376
    buffer_load_dwordx4 v5, s[20:23], s83 offen lds
    s_xor_b32 s82, s67, 3
    s_mul_i32 s82, s82, 2048
    s_lshl_b32 s83, s67, 5
    v_xor_b32 v10, s82, v10
    v_xor_b32 v11, s82, v11
    v_xor_b32 v12, s82, v12
    v_xor_b32 v6, s83, v6
    v_xor_b32 v7, s83, v7
    v_xor_b32 v8, s83, v8
    v_xor_b32 v9, s83, v9
    v_mfma_f32_32x32x16_bf16 v[76:91], v[40:43], v[148:151], v[76:91]
    v_and_b32 v131, 0xffff0000, v139
    v_add_f32 v132, v124, v125
    s_waitcnt vmcnt(5)
    s_waitcnt lgkmcnt(0)
    s_barrier
    v_mfma_f32_32x32x16_bf16 v[44:59], v[92:95], v[152:155], v[44:59]
    v_add_f32 v133, v126, v127
    v_add_f32 v134, v128, v129
    s_mul_i32 s82, s7, 3
    s_lshl_b32 s83, s6, 3
    s_add_u32 s82, s82, s83
    s_lshl_b32 s82, s82, 7
    s_add_u32 s82, s82, 159744
    v_and_b32 v17, 31, v1
    v_lshlrev_b32 v17, 2, v17
    v_add_u32 v17, s82, v17
    v_mov_b32 v18, v13
    ds_read_b64_tr_b16 v[32:33], v10 offset:8192
    ds_read_b64_tr_b16 v[34:35], v10 offset:8704
    ds_read_b128 v[160:163], v6 offset:16384
    v_mfma_f32_32x32x16_bf16 v[60:75], v[96:99], v[152:155], v[60:75]
    v_add_f32 v135, v130, v131
    v_add_f32 v132, v132, v133
    v_add_f32 v134, v134, v135
    v_permlane32_swap_b32 v18, v13
    v_add_f32 v13, v18, v13
    ds_read_b64_tr_b16 v[36:37], v11 offset:16384
    ds_read_b64_tr_b16 v[38:39], v11 offset:16896
    v_mfma_f32_32x32x16_bf16 v[76:91], v[100:103], v[152:155], v[76:91]
    v_add_f32 v132, v132, v134
    s_nop 1
    v_add_f32_dpp v132, v132, v132 row_shr:1 row_mask:0xf bank_mask:0xf bound_ctrl:0
    ds_write_b32 v17, v13 offset:0
    v_mov_b32 v18, v14
    ds_read_b64_tr_b16 v[40:41], v12 offset:16384
    ds_read_b64_tr_b16 v[42:43], v12 offset:16896
    v_mfma_f32_32x32x16_bf16 v[44:59], v[20:23], v[156:159], v[44:59]
    v_add_f32_dpp v132, v132, v132 row_shr:2 row_mask:0xf bank_mask:0xf bound_ctrl:0
    s_nop 1
    v_add_f32_dpp v132, v132, v132 row_shr:4 row_mask:0xf bank_mask:0xf bound_ctrl:0
    v_permlane32_swap_b32 v18, v14
    v_add_f32 v14, v18, v14
    ds_read_b64_tr_b16 v[92:93], v10 offset:10240
    ds_read_b64_tr_b16 v[94:95], v10 offset:10752
    ds_read_b128 v[164:167], v7 offset:16384
    v_mfma_f32_32x32x16_bf16 v[60:75], v[24:27], v[156:159], v[60:75]
    v_add_f32_dpp v132, v132, v132 row_shr:8 row_mask:0xf bank_mask:0xf bound_ctrl:0
    s_nop 1
    v_add_f32_dpp v132, v132, v132 row_bcast:15 row_mask:0xa bank_mask:0xf
    ds_write_b32 v17, v14 offset:128
    ds_read_b64_tr_b16 v[96:97], v11 offset:18432
    ds_read_b64_tr_b16 v[98:99], v11 offset:18944
    v_mfma_f32_32x32x16_bf16 v[76:91], v[28:31], v[156:159], v[76:91]
    v_add_f32_dpp v132, v132, v132 row_bcast:31 row_mask:0xc bank_mask:0xf
    s_nop 0
    v_readlane_b32 s90, v132, 63
    v_mov_b32 v18, v15
    s_nop 1
    v_permlane32_swap_b32 v18, v15
    ds_read_b64_tr_b16 v[100:101], v12 offset:18432
    s_waitcnt lgkmcnt(14)
    ds_read_b64_tr_b16 v[102:103], v12 offset:18944
    s_waitcnt lgkmcnt(8)
    v_mfma_f32_32x32x16_bf16 v[44:59], v[32:35], v[160:163], v[44:59]
    v_mov_b32 v133, 0x3b124925
    v_mul_f32 v133, s90, v133
    v_add_f32 v15, v18, v15
    ds_write_b32 v17, v15 offset:256
    ds_read_b64_tr_b16 v[20:21], v10 offset:12288
    ds_read_b64_tr_b16 v[22:23], v10 offset:12800
    ds_read_b128 v[168:171], v8 offset:16384
    v_mfma_f32_32x32x16_bf16 v[60:75], v[36:39], v[160:163], v[60:75]
    v_cmp_gt_u32 s[92:93], 56, v1
    v_mov_b32 v132, 0
    s_nop 0
    v_cndmask_b32 v134, 0, v133, s[92:93]
    s_add_u32 m0, s66, 0
    s_lshl_b32 s82, s73, 7
    buffer_load_dwordx4 v2, s[8:11], s82 offen lds
    s_add_u32 m0, s66, 8192
    s_lshl_b32 s82, s73, 7
    s_add_u32 s82, s82, 57344
    buffer_load_dwordx4 v2, s[8:11], s82 offen lds
    ds_read_b64_tr_b16 v[24:25], v11 offset:20480
    ds_read_b64_tr_b16 v[26:27], v11 offset:20992
    v_mfma_f32_32x32x16_bf16 v[76:91], v[40:43], v[160:163], v[76:91]
    v_sub_f32 v124, v124, v134
    v_sub_f32 v125, v125, v134
    s_add_u32 m0, s66, 98304
    s_mul_i32 s82, s73, 172032
    buffer_load_dwordx4 v3, s[12:15], s82 offen lds
    s_add_u32 m0, s66, 49152
    s_mul_i32 s83, s73, 229376
    buffer_load_dwordx4 v4, s[16:19], s83 offen lds
    ds_read_b64_tr_b16 v[28:29], v12 offset:20480
    s_waitcnt lgkmcnt(14)
    ds_read_b64_tr_b16 v[30:31], v12 offset:20992
    s_waitcnt lgkmcnt(8)
    v_mfma_f32_32x32x16_bf16 v[44:59], v[92:95], v[164:167], v[44:59]
    v_sub_f32 v126, v126, v134
    v_sub_f32 v127, v127, v134
    s_add_u32 m0, s66, 57344
    s_mul_i32 s83, s73, 229376
    buffer_load_dwordx4 v5, s[20:23], s83 offen lds
    ds_read_b64_tr_b16 v[32:33], v10 offset:14336
    ds_read_b64_tr_b16 v[34:35], v10 offset:14848
    ds_read_b128 v[172:175], v9 offset:16384
    ds_read_b64_tr_b16 v[36:37], v11 offset:22528
    ds_read_b64_tr_b16 v[38:39], v11 offset:23040
    ds_read_b64_tr_b16 v[40:41], v12 offset:22528
    ds_read_b64_tr_b16 v[42:43], v12 offset:23040
    v_mfma_f32_32x32x16_bf16 v[60:75], v[96:99], v[164:167], v[60:75]
    v_sub_f32 v128, v128, v134
    v_sub_f32 v129, v129, v134
    v_mfma_f32_32x32x16_bf16 v[76:91], v[100:103], v[164:167], v[76:91]
    v_sub_f32 v130, v130, v134
    v_sub_f32 v131, v131, v134
    s_waitcnt vmcnt(5)
    s_waitcnt lgkmcnt(0)
    s_barrier
    v_mfma_f32_32x32x16_bf16 v[44:59], v[20:23], v[168:171], v[44:59]
    s_lshr_b32 s82, s2, 3
    s_and_b32 s83, s2, 7
    s_cmp_lt_u32 s82, 28
    s_cselect_b32 s80, 1, 0
    s_min_u32 s82, s82, 27
    s_mul_i32 s84, s82, 37
    s_lshr_b32 s84, s84, 8
    s_mul_i32 s85, s84, 7
    s_sub_u32 s78, s82, s85
    s_lshl_b32 s83, s83, 2
    s_add_u32 s77, s83, s84
    s_lshl_b32 s84, s84, 1
    s_add_u32 s79, s78, s84
    s_sub_u32 s84, s79, 7
    s_cmp_ge_u32 s79, 7
    s_cselect_b32 s79, s84, s79
    s_mul_i32 s56, s79, 229376
    s_add_u32 s57, s56, 229376
    s_cmp_eq_u32 s57, 1605632
    s_cselect_b32 s57, 0, s57
    v_mul_f32 v135, v124, v124
    v_fmac_f32 v132, v125, v125
    v_fmac_f32 v135, v126, v126
    s_add_u32 m0, s66, 16384
    s_lshl_b32 s82, s74, 7
    buffer_load_dwordx4 v2, s[8:11], s82 offen lds
    ds_read_b64_tr_b16 v[92:93], v10 offset:16384
    ds_read_b64_tr_b16 v[94:95], v10 offset:16896
    ds_read_b128 v[176:179], v6 offset:32768
    v_mfma_f32_32x32x16_bf16 v[60:75], v[24:27], v[168:171], v[60:75]
    s_add_u32 s58, s57, 229376
    s_cmp_eq_u32 s58, 1605632
    s_cselect_b32 s58, 0, s58
    s_add_u32 s59, s58, 229376
    s_cmp_eq_u32 s59, 1605632
    s_cselect_b32 s59, 0, s59
    v_fmac_f32 v132, v127, v127
    v_fmac_f32 v135, v128, v128
    ds_read_b64_tr_b16 v[96:97], v11 offset:32768
    ds_read_b64_tr_b16 v[98:99], v11 offset:33280
    v_mfma_f32_32x32x16_bf16 v[76:91], v[28:31], v[168:171], v[76:91]
    s_add_u32 s60, s59, 229376
    s_cmp_eq_u32 s60, 1605632
    s_cselect_b32 s60, 0, s60
    s_add_u32 s61, s60, 229376
    s_cmp_eq_u32 s61, 1605632
    s_cselect_b32 s61, 0, s61
    v_fmac_f32 v132, v129, v129
    v_fmac_f32 v135, v130, v130
    s_add_u32 m0, s66, 24576
    s_lshl_b32 s82, s74, 7
    s_add_u32 s82, s82, 57344
    buffer_load_dwordx4 v2, s[8:11], s82 offen lds
    ds_read_b64_tr_b16 v[100:101], v12 offset:32768
    ds_read_b64_tr_b16 v[102:103], v12 offset:33280
    v_mfma_f32_32x32x16_bf16 v[44:59], v[32:35], v[172:175], v[44:59]
    s_add_u32 s62, s61, 229376
    s_cmp_eq_u32 s62, 1605632
    s_cselect_b32 s62, 0, s62
    s_lshl_b32 s82, s77, 1
    s_add_u32 s82, s82, s7
    s_mul_i32 s43, s82, 32768
    s_lshl_b32 s83, s6, 10
    s_add_u32 s43, s43, s83
    s_add_u32 s43, s43, 16777216
    s_cmp_ge_u32 s82, 56
    s_cselect_b32 s63, 1376256, 0
    s_lshl_b32 s82, s82, 12
    s_add_u32 s63, s63, s82
    s_add_u32 s63, s63, 22020096
    s_bitcmp1_b32 s6, 0
    s_cselect_b32 s83, 3211264, 0
    s_add_u32 s63, s63, s83
    s_lshr_b32 s83, s6, 1
    s_lshl_b32 s83, s83, 11
    s_add_u32 s63, s63, s83
    s_cmp_eq_u32 s80, 0
    s_cselect_b32 s82, 0x4000000, 0
    s_add_u32 s63, s63, s82
    v_fmac_f32 v132, v131, v131
    v_add_f32 v132, v132, v135
    ds_read_b64_tr_b16 v[20:21], v10 offset:18432
    ds_read_b64_tr_b16 v[22:23], v10 offset:18944
    ds_read_b128 v[180:183], v7 offset:32768
    v_mfma_f32_32x32x16_bf16 v[60:75], v[36:39], v[172:175], v[60:75]
    s_mul_i32 s101, s5, 3072
    s_lshr_b32 s82, s4, 1
    s_mul_i32 s82, s82, 1792
    s_bitcmp1_b32 s4, 0
    s_cselect_b32 s83, 768, 0
    s_add_u32 s82, s82, s83
    s_lshl_b32 s41, s4, 10
    s_sub_u32 s41, s41, s82
    s_add_u32 s41, s41, 2097152
    s_lshl_b32 s83, s3, 3
    s_add_u32 s42, s83, s5
    s_lshl_b32 s42, s42, 14
    s_add_u32 s42, s42, s82
    s_add_u32 s42, s42, 1048576
    s_add_u32 s69, s82, 3145728
    s_mul_i32 s82, s5, 3
    s_lshl_b32 s83, s3, 3
    s_add_u32 s83, s83, s82
    s_sub_i32 s83, s83, 16
    s_and_b32 s84, s83, 1
    s_max_i32 s83, s83, s84
    s_lshl_b32 s83, s83, 14
    s_add_u32 s0, s69, s83
    v_add_f32_dpp v132, v132, v132 row_shr:1 row_mask:0xf bank_mask:0xf bound_ctrl:0
    s_nop 1
    v_add_f32_dpp v132, v132, v132 row_shr:2 row_mask:0xf bank_mask:0xf bound_ctrl:0
    s_add_u32 m0, s66, 106496
    s_mul_i32 s82, s74, 172032
    buffer_load_dwordx4 v3, s[12:15], s82 offen lds
    ds_read_b64_tr_b16 v[24:25], v11 offset:34816
    ds_read_b64_tr_b16 v[26:27], v11 offset:35328
    v_mfma_f32_32x32x16_bf16 v[76:91], v[40:43], v[172:175], v[76:91]
    s_mul_i32 s82, s5, 3
    s_lshl_b32 s83, s3, 3
    s_add_u32 s83, s83, s82
    s_sub_i32 s83, s83, 15
    s_and_b32 s84, s83, 1
    s_max_i32 s83, s83, s84
    s_lshl_b32 s83, s83, 14
    s_add_u32 s1, s69, s83
    s_mul_i32 s82, s5, 3
    s_lshl_b32 s83, s3, 3
    s_add_u32 s83, s83, s82
    s_sub_i32 s83, s83, 14
    s_and_b32 s84, s83, 1
    s_max_i32 s83, s83, s84
    s_lshl_b32 s83, s83, 14
    s_add_u32 s69, s69, s83
    v_add_f32_dpp v132, v132, v132 row_shr:4 row_mask:0xf bank_mask:0xf bound_ctrl:0
    s_nop 1
    v_add_f32_dpp v132, v132, v132 row_shr:8 row_mask:0xf bank_mask:0xf bound_ctrl:0
    ds_read_b64_tr_b16 v[28:29], v12 offset:34816
    ds_read_b64_tr_b16 v[30:31], v12 offset:35328
    s_waitcnt lgkmcnt(7)
    v_mfma_f32_32x32x16_bf16 v[44:59], v[92:95], v[176:179], v[44:59]
    v_add_f32_dpp v132, v132, v132 row_bcast:15 row_mask:0xa bank_mask:0xf
    s_nop 1
    v_add_f32_dpp v132, v132, v132 row_bcast:31 row_mask:0xc bank_mask:0xf
    s_nop 0
    v_readlane_b32 s90, v132, 63
    s_add_u32 m0, s66, 65536
    s_mul_i32 s83, s74, 229376
    buffer_load_dwordx4 v4, s[16:19], s83 offen lds
    v_and_b32 v17, 0xff, v0
    v_lshlrev_b32 v17, 2, v17
    ds_read_b64_tr_b16 v[32:33], v10 offset:20480
    ds_read_b64_tr_b16 v[34:35], v10 offset:20992
    ds_read_b128 v[184:187], v8 offset:32768
    v_mfma_f32_32x32x16_bf16 v[60:75], v[96:99], v[176:179], v[60:75]
    v_mov_b32 v134, 0x3b124925
    v_mov_b32 v126, 0x3727c5ac
    v_add_u32 v18, 159744, v17
    ds_read_b64_tr_b16 v[36:37], v11 offset:36864
    ds_read_b64_tr_b16 v[38:39], v11 offset:37376
    v_mfma_f32_32x32x16_bf16 v[76:91], v[100:103], v[176:179], v[76:91]
    v_fmac_f32 v126, s90, v134
    v_cmp_eq_u32 s[92:93], 0, v1
    s_add_u32 m0, s66, 73728
    s_mul_i32 s83, s74, 229376
    buffer_load_dwordx4 v5, s[20:23], s83 offen lds
    ds_read_b32 v140, v18
    ds_read_b32 v141, v18 offset:1024
    ds_read_b64_tr_b16 v[40:41], v12 offset:36864
    s_waitcnt lgkmcnt(14)
    ds_read_b64_tr_b16 v[42:43], v12 offset:37376
    s_waitcnt lgkmcnt(9)
    v_mfma_f32_32x32x16_bf16 v[44:59], v[20:23], v[180:183], v[44:59]
    v_rsq_f32 v124, v126
    v_mov_b32 v125, v133
    ds_read_b32 v142, v18 offset:2048
    ds_read_b64_tr_b16 v[92:93], v10 offset:22528
    ds_read_b64_tr_b16 v[94:95], v10 offset:23040
    ds_read_b128 v[188:191], v9 offset:32768
    ds_read_b64_tr_b16 v[96:97], v11 offset:38912
    ds_read_b64_tr_b16 v[98:99], v11 offset:39424
    s_waitcnt lgkmcnt(14)
    ds_read_b64_tr_b16 v[100:101], v12 offset:38912
    s_waitcnt lgkmcnt(14)
    ds_read_b64_tr_b16 v[102:103], v12 offset:39424
    v_mfma_f32_32x32x16_bf16 v[60:75], v[24:27], v[180:183], v[60:75]
    v_mov_b32 v127, s64
    v_mov_b32 v128, 0x7ffffff0
    s_waitcnt lgkmcnt(14)
    ds_read_b32 v143, v18 offset:3072
    v_lshlrev_b32 v17, 1, v17
    v_mfma_f32_32x32x16_bf16 v[76:91], v[28:31], v[180:183], v[76:91]
    v_cndmask_b32 v128, v128, 0, s[92:93]
    buffer_store_dwordx4 v[124:127], v128, s[36:39], s68 offen sc1
    s_lshl_b32 s82, s4, 5
    s_add_u32 s82, s82, s40
    s_lshl_b32 s82, s82, 11
    s_add_u32 s82, s82, 19922944
    s_cmp_lt_u32 s5, 4
    s_cselect_b32 s82, s82, 0x7ffffff0
    s_waitcnt lgkmcnt(11)
    v_add_f32 v140, v140, v141
    s_waitcnt lgkmcnt(0)
    v_add_f32 v142, v142, v143
    v_mov_b32 v141, s64
    v_add_f32 v140, v140, v142
    buffer_store_dwordx2 v[140:141], v17, s[36:39], s82 offen sc1
    s_waitcnt vmcnt(7)
    s_barrier
    v_mfma_f32_32x32x16_bf16 v[44:59], v[32:35], v[184:187], v[44:59]
    s_add_u32 m0, s66, 32768
    s_lshl_b32 s82, s75, 7
    buffer_load_dwordx4 v2, s[8:11], s82 offen lds
    ds_read_b64_tr_b16 v[20:21], v10 offset:0
    ds_read_b64_tr_b16 v[22:23], v10 offset:512
    ds_read_b128 v[192:195], v6 offset:0
    v_mfma_f32_32x32x16_bf16 v[60:75], v[36:39], v[184:187], v[60:75]
    ds_read_b64_tr_b16 v[24:25], v11 offset:0
    ds_read_b64_tr_b16 v[26:27], v11 offset:512
    v_mfma_f32_32x32x16_bf16 v[76:91], v[40:43], v[184:187], v[76:91]
    s_add_u32 m0, s66, 40960
    s_lshl_b32 s82, s75, 7
    s_add_u32 s82, s82, 57344
    buffer_load_dwordx4 v2, s[8:11], s82 offen lds
    ds_read_b64_tr_b16 v[28:29], v12 offset:0
    ds_read_b64_tr_b16 v[30:31], v12 offset:512
    v_mfma_f32_32x32x16_bf16 v[44:59], v[92:95], v[188:191], v[44:59]
    ds_read_b64_tr_b16 v[32:33], v10 offset:2048
    ds_read_b64_tr_b16 v[34:35], v10 offset:2560
    ds_read_b128 v[196:199], v7 offset:0
    v_mfma_f32_32x32x16_bf16 v[60:75], v[96:99], v[188:191], v[60:75]
    s_add_u32 m0, s66, 114688
    s_mul_i32 s82, s75, 172032
    buffer_load_dwordx4 v3, s[12:15], s82 offen lds
    ds_read_b64_tr_b16 v[36:37], v11 offset:2048
    ds_read_b64_tr_b16 v[38:39], v11 offset:2560
    v_mfma_f32_32x32x16_bf16 v[76:91], v[100:103], v[188:191], v[76:91]
    ds_read_b64_tr_b16 v[40:41], v12 offset:2048
    ds_read_b64_tr_b16 v[42:43], v12 offset:2560
    s_waitcnt lgkmcnt(7)
    v_mfma_f32_32x32x16_bf16 v[44:59], v[20:23], v[192:195], v[44:59]
    s_add_u32 m0, s66, 81920
    s_mul_i32 s83, s75, 229376
    buffer_load_dwordx4 v4, s[16:19], s83 offen lds
    ds_read_b64_tr_b16 v[92:93], v10 offset:4096
    ds_read_b64_tr_b16 v[94:95], v10 offset:4608
    ds_read_b128 v[200:203], v8 offset:0
    v_mfma_f32_32x32x16_bf16 v[60:75], v[24:27], v[192:195], v[60:75]
    ds_read_b64_tr_b16 v[96:97], v11 offset:4096
    ds_read_b64_tr_b16 v[98:99], v11 offset:4608
    v_mfma_f32_32x32x16_bf16 v[76:91], v[28:31], v[192:195], v[76:91]
    s_add_u32 m0, s66, 90112
    s_mul_i32 s83, s75, 229376
    buffer_load_dwordx4 v5, s[20:23], s83 offen lds
    ds_read_b64_tr_b16 v[100:101], v12 offset:4096
    ds_read_b64_tr_b16 v[102:103], v12 offset:4608
    s_waitcnt lgkmcnt(7)
    v_mfma_f32_32x32x16_bf16 v[44:59], v[32:35], v[196:199], v[44:59]
    ds_read_b64_tr_b16 v[20:21], v10 offset:6144
    ds_read_b64_tr_b16 v[22:23], v10 offset:6656
    ds_read_b128 v[204:207], v9 offset:0
    ds_read_b64_tr_b16 v[24:25], v11 offset:6144
    ds_read_b64_tr_b16 v[26:27], v11 offset:6656
    ds_read_b64_tr_b16 v[28:29], v12 offset:6144
    ds_read_b64_tr_b16 v[30:31], v12 offset:6656
    v_mfma_f32_32x32x16_bf16 v[60:75], v[36:39], v[196:199], v[60:75]
    v_mfma_f32_32x32x16_bf16 v[76:91], v[40:43], v[196:199], v[76:91]
    s_waitcnt vmcnt(7)
    s_waitcnt lgkmcnt(0)
    s_barrier
    v_mfma_f32_32x32x16_bf16 v[44:59], v[92:95], v[200:203], v[44:59]
    s_add_u32 m0, s66, 0
    s_lshl_b32 s82, s76, 7
    buffer_load_dwordx4 v2, s[8:11], s82 offen lds
    ds_read_b64_tr_b16 v[32:33], v10 offset:8192
    ds_read_b64_tr_b16 v[34:35], v10 offset:8704
    ds_read_b128 v[208:211], v6 offset:16384
    v_mfma_f32_32x32x16_bf16 v[60:75], v[96:99], v[200:203], v[60:75]
    ds_read_b64_tr_b16 v[36:37], v11 offset:16384
    ds_read_b64_tr_b16 v[38:39], v11 offset:16896
    v_mfma_f32_32x32x16_bf16 v[76:91], v[100:103], v[200:203], v[76:91]
    s_add_u32 m0, s66, 8192
    s_lshl_b32 s82, s76, 7
    s_add_u32 s82, s82, 57344
    buffer_load_dwordx4 v2, s[8:11], s82 offen lds
    ds_read_b64_tr_b16 v[40:41], v12 offset:16384
    ds_read_b64_tr_b16 v[42:43], v12 offset:16896
    v_mfma_f32_32x32x16_bf16 v[44:59], v[20:23], v[204:207], v[44:59]
    ds_read_b64_tr_b16 v[92:93], v10 offset:10240
    ds_read_b64_tr_b16 v[94:95], v10 offset:10752
    ds_read_b128 v[212:215], v7 offset:16384
    v_mfma_f32_32x32x16_bf16 v[60:75], v[24:27], v[204:207], v[60:75]
    s_add_u32 m0, s66, 98304
    s_mul_i32 s82, s76, 172032
    buffer_load_dwordx4 v3, s[12:15], s82 offen lds
    ds_read_b64_tr_b16 v[96:97], v11 offset:18432
    ds_read_b64_tr_b16 v[98:99], v11 offset:18944
    v_mfma_f32_32x32x16_bf16 v[76:91], v[28:31], v[204:207], v[76:91]
    ds_read_b64_tr_b16 v[100:101], v12 offset:18432
    ds_read_b64_tr_b16 v[102:103], v12 offset:18944
    s_waitcnt lgkmcnt(7)
    v_mfma_f32_32x32x16_bf16 v[44:59], v[32:35], v[208:211], v[44:59]
    s_add_u32 m0, s66, 49152
    s_mul_i32 s83, s76, 229376
    buffer_load_dwordx4 v4, s[16:19], s83 offen lds
    s_and_b32 s82, s3, 7
    s_mul_i32 s82, s82, 200704
    s_lshl_b32 s83, s4, 8
    s_add_u32 s82, s82, s83
    s_movk_i32 s83, 3584
    v_min_u32 v108, 55, v1
    v_mul_u32_u24 v108, s83, v108
    s_cmp_eq_u32 s5, 0
    s_cselect_b32 s83, s82, 0x7ffffff0
    buffer_load_dword v110, v108, s[16:19], s83 offen offset:128
    s_cmp_eq_u32 s5, 1
    s_cselect_b32 s83, s82, 0x7ffffff0
    buffer_load_dword v111, v108, s[20:23], s83 offen offset:128
    ds_read_b64_tr_b16 v[20:21], v10 offset:12288
    ds_read_b64_tr_b16 v[22:23], v10 offset:12800
    ds_read_b128 v[216:219], v8 offset:16384
    v_mfma_f32_32x32x16_bf16 v[60:75], v[36:39], v[208:211], v[60:75]
    ds_read_b64_tr_b16 v[24:25], v11 offset:20480
    ds_read_b64_tr_b16 v[26:27], v11 offset:20992
    v_mfma_f32_32x32x16_bf16 v[76:91], v[40:43], v[208:211], v[76:91]
    s_add_u32 m0, s66, 57344
    s_mul_i32 s83, s76, 229376
    buffer_load_dwordx4 v5, s[20:23], s83 offen lds
    ds_read_b64_tr_b16 v[28:29], v12 offset:20480
    ds_read_b64_tr_b16 v[30:31], v12 offset:20992
    s_waitcnt lgkmcnt(7)
    v_mfma_f32_32x32x16_bf16 v[44:59], v[92:95], v[212:215], v[44:59]
    ds_read_b64_tr_b16 v[32:33], v10 offset:14336
    ds_read_b64_tr_b16 v[34:35], v10 offset:14848
    ds_read_b128 v[220:223], v9 offset:16384
    ds_read_b64_tr_b16 v[36:37], v11 offset:22528
    ds_read_b64_tr_b16 v[38:39], v11 offset:23040
    ds_read_b64_tr_b16 v[40:41], v12 offset:22528
    ds_read_b64_tr_b16 v[42:43], v12 offset:23040
    v_mfma_f32_32x32x16_bf16 v[60:75], v[96:99], v[212:215], v[60:75]
    v_mfma_f32_32x32x16_bf16 v[76:91], v[100:103], v[212:215], v[76:91]
    s_waitcnt vmcnt(7)
    s_waitcnt lgkmcnt(0)
    s_barrier
    v_mfma_f32_32x32x16_bf16 v[44:59], v[20:23], v[216:219], v[44:59]
    s_cmp_ge_u32 s5, 3
    s_cbranch_scc1 csi_2
    v_lshlrev_b32 v2, 3, v0
    s_lshl_b32 s96, s4, 16
    s_add_u32 s96, s96, 19922944
    s_add_u32 s97, s96, 4096
    s_add_u32 s98, s96, 8192
    s_add_u32 s99, s96, 12288
    buffer_load_dwordx2 v[130:131], v2, s[36:39], s96 offen offset:0 sc1
    buffer_load_dwordx2 v[132:133], v2, s[36:39], s96 offen offset:2048 sc1
    buffer_load_dwordx2 v[134:135], v2, s[36:39], s97 offen offset:0 sc1
    buffer_load_dwordx2 v[136:137], v2, s[36:39], s97 offen offset:2048 sc1
    buffer_load_dwordx2 v[138:139], v2, s[36:39], s98 offen offset:0 sc1
    buffer_load_dwordx2 v[140:141], v2, s[36:39], s98 offen offset:2048 sc1
    buffer_load_dwordx2 v[142:143], v2, s[36:39], s99 offen offset:0 sc1
csi_2:
    ds_read_b64_tr_b16 v[92:93], v10 offset:16384
    ds_read_b64_tr_b16 v[94:95], v10 offset:16896
    ds_read_b128 v[224:227], v6 offset:32768
    v_mfma_f32_32x32x16_bf16 v[60:75], v[24:27], v[216:219], v[60:75]
    s_add_u32 m0, s66, 16256
    s_mul_i32 s83, s70, 229376
    buffer_load_dwordx4 v4, s[16:19], s83 offen offset:128 lds
    ds_read_b64_tr_b16 v[96:97], v11 offset:32768
    ds_read_b64_tr_b16 v[98:99], v11 offset:33280
    v_mfma_f32_32x32x16_bf16 v[76:91], v[28:31], v[216:219], v[76:91]
    s_add_u32 m0, s66, 24448
    s_mul_i32 s83, s70, 229376
    buffer_load_dwordx4 v5, s[20:23], s83 offen offset:128 lds
    ds_read_b64_tr_b16 v[100:101], v12 offset:32768
    ds_read_b64_tr_b16 v[102:103], v12 offset:33280
    v_mfma_f32_32x32x16_bf16 v[44:59], v[32:35], v[220:223], v[44:59]
    ds_read_b64_tr_b16 v[20:21], v10 offset:18432
    ds_read_b64_tr_b16 v[22:23], v10 offset:18944
    ds_read_b128 v[228:231], v7 offset:32768
    v_mfma_f32_32x32x16_bf16 v[60:75], v[36:39], v[220:223], v[60:75]
    s_add_u32 m0, s66, 65408
    s_mul_i32 s83, s71, 229376
    buffer_load_dwordx4 v4, s[16:19], s83 offen offset:128 lds
    ds_read_b64_tr_b16 v[24:25], v11 offset:34816
    ds_read_b64_tr_b16 v[26:27], v11 offset:35328
    v_mfma_f32_32x32x16_bf16 v[76:91], v[40:43], v[220:223], v[76:91]
    s_add_u32 m0, s66, 73600
    s_mul_i32 s83, s71, 229376
    buffer_load_dwordx4 v5, s[20:23], s83 offen offset:128 lds
    ds_read_b64_tr_b16 v[28:29], v12 offset:34816
    ds_read_b64_tr_b16 v[30:31], v12 offset:35328
    s_waitcnt lgkmcnt(7)
    v_mfma_f32_32x32x16_bf16 v[44:59], v[92:95], v[224:227], v[44:59]
    s_lshl_b32 s82, s2, 13
    s_cmp_eq_u32 s5, 3
    s_cselect_b32 s83, 0, 0x7ffffff0
    v_lshlrev_b32 v112, 7, v1
    v_add_u32 v112, s82, v112
    buffer_load_dword v113, v112, s[24:27], s83 offen
    v_subrev_u32 v112, 1605632, v112
    buffer_load_dword v114, v112, s[28:31], s83 offen
    ds_read_b64_tr_b16 v[32:33], v10 offset:20480
    ds_read_b64_tr_b16 v[34:35], v10 offset:20992
    ds_read_b128 v[232:235], v8 offset:32768
    v_mfma_f32_32x32x16_bf16 v[60:75], v[96:99], v[224:227], v[60:75]
    s_add_u32 m0, s66, 122752
    s_mul_i32 s83, s73, 229376
    buffer_load_dwordx4 v4, s[16:19], s83 offen offset:128 lds
    s_lshl_b32 s82, s3, 2
    s_add_u32 s82, s82, s6
    s_lshl_b32 s82, s82, 4
    s_add_u32 s82, s82, s4
    s_lshl_b32 s82, s82, 5
    s_add_u32 s82, s82, 262144
    s_cmp_eq_u32 s7, 0
    s_cselect_b32 s82, s82, 0x7ffffff0
    v_min_u32 v116, 2, v1
    v_lshlrev_b32 v116, 17, v116
    buffer_load_dword v117, v116, s[36:39], s82 offen sc1
    ds_read_b64_tr_b16 v[36:37], v11 offset:36864
    ds_read_b64_tr_b16 v[38:39], v11 offset:37376
    v_mfma_f32_32x32x16_bf16 v[76:91], v[100:103], v[224:227], v[76:91]
    s_add_u32 m0, s66, 130944
    s_mul_i32 s83, s73, 229376
    buffer_load_dwordx4 v5, s[20:23], s83 offen offset:128 lds
    ds_read_b64_tr_b16 v[40:41], v12 offset:36864
    ds_read_b64_tr_b16 v[42:43], v12 offset:37376
    s_waitcnt lgkmcnt(7)
    v_mfma_f32_32x32x16_bf16 v[44:59], v[20:23], v[228:231], v[44:59]
    s_lshl_b32 s68, s3, 2
    s_add_u32 s68, s68, s6
    s_lshl_b32 s68, s68, 9
    s_add_u32 s68, s68, 131072
    v_and_b32 v128, 31, v1
    v_lshlrev_b32 v128, 4, v128
    ds_read_b64_tr_b16 v[92:93], v10 offset:22528
    ds_read_b64_tr_b16 v[94:95], v10 offset:23040
    ds_read_b128 v[236:239], v9 offset:32768
    ds_read_b64_tr_b16 v[96:97], v11 offset:38912
    ds_read_b64_tr_b16 v[98:99], v11 offset:39424
    ds_read_b64_tr_b16 v[100:101], v12 offset:38912
    ds_read_b64_tr_b16 v[102:103], v12 offset:39424
    v_mfma_f32_32x32x16_bf16 v[60:75], v[24:27], v[228:231], v[60:75]
    buffer_load_dwordx4 v[124:127], v128, s[36:39], s68 offen sc1
    v_mfma_f32_32x32x16_bf16 v[76:91], v[28:31], v[228:231], v[76:91]
    s_waitcnt vmcnt(10)
    s_waitcnt lgkmcnt(0)
    s_barrier
    v_mfma_f32_32x32x16_bf16 v[44:59], v[32:35], v[232:235], v[44:59]
    s_add_u32 m0, s66, 32640
    s_mul_i32 s83, s72, 229376
    buffer_load_dwordx4 v4, s[16:19], s83 offen offset:128 lds
    ds_read_b64_tr_b16 v[20:21], v10 offset:0
    ds_read_b64_tr_b16 v[22:23], v10 offset:512
    ds_read_b128 v[240:243], v6 offset:0
    v_mfma_f32_32x32x16_bf16 v[60:75], v[36:39], v[232:235], v[60:75]
    ds_read_b64_tr_b16 v[24:25], v11 offset:0
    ds_read_b64_tr_b16 v[26:27], v11 offset:512
    v_mfma_f32_32x32x16_bf16 v[76:91], v[40:43], v[232:235], v[76:91]
    s_add_u32 m0, s66, 40832
    s_mul_i32 s83, s72, 229376
    buffer_load_dwordx4 v5, s[20:23], s83 offen offset:128 lds
    ds_read_b64_tr_b16 v[28:29], v12 offset:0
    ds_read_b64_tr_b16 v[30:31], v12 offset:512
    v_mfma_f32_32x32x16_bf16 v[44:59], v[92:95], v[236:239], v[44:59]
    ds_read_b64_tr_b16 v[32:33], v10 offset:2048
    ds_read_b64_tr_b16 v[34:35], v10 offset:2560
    ds_read_b128 v[244:247], v7 offset:0
    v_mfma_f32_32x32x16_bf16 v[60:75], v[96:99], v[236:239], v[60:75]
    s_add_u32 m0, s66, 139136
    s_mul_i32 s83, s74, 229376
    buffer_load_dwordx4 v4, s[16:19], s83 offen offset:128 lds
    ds_read_b64_tr_b16 v[36:37], v11 offset:2048
    ds_read_b64_tr_b16 v[38:39], v11 offset:2560
    v_mfma_f32_32x32x16_bf16 v[76:91], v[100:103], v[236:239], v[76:91]
    ds_read_b64_tr_b16 v[40:41], v12 offset:2048
    ds_read_b64_tr_b16 v[42:43], v12 offset:2560
    s_waitcnt lgkmcnt(7)
    v_mfma_f32_32x32x16_bf16 v[44:59], v[20:23], v[240:243], v[44:59]
    s_add_u32 m0, s66, 147328
    s_mul_i32 s83, s74, 229376
    buffer_load_dwordx4 v5, s[20:23], s83 offen offset:128 lds
    s_cmp_ge_u32 s5, 3
    s_waitcnt vmcnt(14)
    s_cbranch_scc1 csf_3
    v_xor_b32 v17, s64, v131
    v_mov_b32 v18, s64
    v_bitop3_b32 v17, v133, v18, v17 bitop3:0xbe
    v_bitop3_b32 v17, v135, v18, v17 bitop3:0xbe
    v_bitop3_b32 v17, v137, v18, v17 bitop3:0xbe
    v_bitop3_b32 v17, v139, v18, v17 bitop3:0xbe
    v_bitop3_b32 v17, v141, v18, v17 bitop3:0xbe
    v_bitop3_b32 v17, v143, v18, v17 bitop3:0xbe
    v_cmp_ne_u32 vcc, 0, v17
    s_cbranch_vccnz chk_4_slow
chk_4_back:
    v_add_f32 v130, v130, v132
    v_add_f32 v134, v134, v136
    v_add_f32 v138, v138, v140
    v_add_f32 v130, v130, v142
    v_add_f32 v134, v134, v138
    v_lshrrev_b32 v17, 1, v2
    v_add_u32 v17, 155648, v17
    v_add_f32 v130, v130, v134
    ds_write_b32 v17, v130
csf_3:
    s_waitcnt vmcnt(4)
    v_cmp_ne_u32 vcc, s64, v127
    s_cbranch_vccnz chk_5_slow
chk_5_back:
    ds_read_b64_tr_b16 v[92:93], v10 offset:4096
    ds_read_b64_tr_b16 v[94:95], v10 offset:4608
    ds_read_b128 v[248:251], v8 offset:0
    v_mfma_f32_32x32x16_bf16 v[60:75], v[24:27], v[240:243], v[60:75]
    v_cmp_gt_u32 vcc, 32, v1
    v_sub_f32 v130, 0, v125
    v_mov_b32 v18, 0
    v_cndmask_b32 v130, 0, v130, vcc
    ds_read_b64_tr_b16 v[96:97], v11 offset:4096
    ds_read_b64_tr_b16 v[98:99], v11 offset:4608
    v_mfma_f32_32x32x16_bf16 v[76:91], v[28:31], v[240:243], v[76:91]
    v_lshrrev_b32 v108, 3, v1
    s_lshl_b32 s82, s5, 3
    v_add_u32 v108, s82, v108
    v_lshrrev_b32 v109, 2, v1
    v_and_b32 v109, 4, v109
    v_and_b32 v110, 7, v1
    v_xor_b32 v109, v109, v110
    v_lshlrev_b32 v109, 4, v109
    s_movk_i32 s83, 896
    v_mad_u32_u24 v3, v108, s83, v109
    s_lshl_b32 s84, s78, 7
    v_add_u32 v3, s84, v3
    v_cvt_pk_bf16_f32 v16, v130, v130
    v_mov_b32 v19, 0
    ds_read_b64_tr_b16 v[100:101], v12 offset:4096
    ds_read_b64_tr_b16 v[102:103], v12 offset:4608
    s_waitcnt lgkmcnt(7)
    v_mfma_f32_32x32x16_bf16 v[44:59], v[32:35], v[244:247], v[44:59]
    v_and_b32 v17, 0xffff0000, v16
    ds_read_b64_tr_b16 v[20:21], v10 offset:6144
    ds_read_b64_tr_b16 v[22:23], v10 offset:6656
    ds_read_b128 v[252:255], v9 offset:0
    ds_read_b64_tr_b16 v[24:25], v11 offset:6144
    ds_read_b64_tr_b16 v[26:27], v11 offset:6656
    ds_read_b64_tr_b16 v[28:29], v12 offset:6144
    ds_read_b64_tr_b16 v[30:31], v12 offset:6656
    v_mfma_f32_32x32x16_bf16 v[60:75], v[36:39], v[244:247], v[60:75]
    v_sub_f32 v130, v130, v17
    v_cvt_pk_bf16_f32 v17, v130, 0
    v_add_u32 v11, 0xffff8000, v11
    v_add_u32 v12, 0xffff8000, v12
    s_lshl_b32 s82, s67, 11
    v_xor_b32 v11, s82, v11
    v_xor_b32 v12, s82, v12
    v_mfma_f32_32x32x16_bf16 v[76:91], v[40:43], v[244:247], v[76:91]
    s_lshl_b32 s68, s3, 2
    s_add_u32 s68, s68, s6
    s_lshl_b32 s68, s68, 4
    s_add_u32 s68, s68, s4
    s_lshl_b32 s68, s68, 3
    s_add_u32 s68, s68, s7
    s_lshl_b32 s68, s68, 2
    s_waitcnt lgkmcnt(0)
    s_barrier
    v_mfma_f32_32x32x16_bf16 v[44:59], v[92:95], v[248:251], v[44:59]
    s_add_u32 m0, s66, 81792
    s_mul_i32 s83, s75, 229376
    buffer_load_dwordx4 v4, s[16:19], s83 offen offset:128 lds
    s_add_u32 m0, s66, 89984
    s_mul_i32 s83, s75, 229376
    buffer_load_dwordx4 v5, s[20:23], s83 offen offset:128 lds
    v_mfma_f32_32x32x16_bf16 v[60:75], v[96:99], v[248:251], v[60:75]
    s_add_u32 m0, s66, 106368
    s_mul_i32 s83, s76, 229376
    buffer_load_dwordx4 v4, s[16:19], s83 offen offset:128 lds
    ds_read_b64_tr_b16 v[32:33], v11 offset:0
    ds_read_b64_tr_b16 v[34:35], v11 offset:512
    v_mfma_f32_32x32x16_bf16 v[76:91], v[100:103], v[248:251], v[76:91]
    s_add_u32 m0, s66, 114560
    s_mul_i32 s83, s76, 229376
    buffer_load_dwordx4 v5, s[20:23], s83 offen offset:128 lds
    ds_read_b64_tr_b16 v[36:37], v12 offset:0
    ds_read_b64_tr_b16 v[38:39], v12 offset:512
    v_mfma_f32_32x32x16_bf16 v[44:59], v[20:23], v[252:255], v[44:59]
    s_lshr_b32 s82, s2, 3
    s_lshl_b32 s82, s82, 15
    s_add_u32 s82, s82, 0
    s_cmp_eq_u32 s7, 0
    s_cselect_b32 s83, 0, 0x7ffffff0
    v_and_b32 v6, 0xff, v0
    v_lshlrev_b32 v6, 7, v6
    v_add_u32 v6, s82, v6
    buffer_load_dword v8, v6, s[24:27], s83 offen
    v_mfma_f32_32x32x16_bf16 v[60:75], v[24:27], v[252:255], v[60:75]
    v_xor_b32 v11, 2048, v11
    ds_read_b64_tr_b16 v[40:41], v11 offset:0
    ds_read_b64_tr_b16 v[42:43], v11 offset:512
    v_mfma_f32_32x32x16_bf16 v[76:91], v[28:31], v[252:255], v[76:91]
    v_xor_b32 v12, 2048, v12
    ds_read_b64_tr_b16 v[28:29], v12 offset:0
    ds_read_b64_tr_b16 v[30:31], v12 offset:512
    s_waitcnt lgkmcnt(4)
    v_mfma_f32_32x32x16_bf16 v[92:107], v[32:35], v[144:147], 0
    v_and_b32 v10, 31, v1
    v_lshlrev_b32 v10, 2, v10
    s_mul_i32 s90, s7, 384
    s_add_u32 s90, s90, 155648
    v_add_u32 v9, s90, v10
    ds_read_b32 v130, v9
    ds_read_b32 v131, v9 offset:128
    ds_read_b32 v132, v9 offset:256
    s_lshl_b32 s90, s7, 8
    v_xor_b32 v11, 6144, v11
    ds_read_b64_tr_b16 v[20:21], v11 offset:0
    ds_read_b64_tr_b16 v[22:23], v11 offset:512
    v_mfma_f32_32x32x16_bf16 v[108:123], v[36:39], v[144:147], 0
    s_add_u32 s90, s90, 156416
    v_add_u32 v10, s90, v10
    v_mov_b32 v138, 0
    v_mov_b32 v139, 0
    s_mov_b32 s95, 0
    s_mov_b32 s93, 3145728
    s_cmp_lt_u32 s4, 7
    s_cselect_b32 s92, 0x3e8b97f6, 1.0
    s_cselect_b32 s93, 1048576, s93
    s_cselect_b32 s94, 0, 7
    v_mul_f32 v129, v124, v124
    v_mul_f32 v128, 0xc0135761, v124
    v_mul_f32 v129, v129, v124
    v_xor_b32 v12, 6144, v12
    ds_read_b64_tr_b16 v[24:25], v12 offset:0
    ds_read_b64_tr_b16 v[26:27], v12 offset:512
    v_mov_b32 v13, 0
    v_mov_b32 v14, 0
    v_dot2c_f32_bf16 v13, s65, v32
    v_dot2c_f32_bf16 v14, s65, v36
    v_dot2c_f32_bf16 v13, s65, v33
    v_dot2c_f32_bf16 v14, s65, v37
    v_dot2c_f32_bf16 v13, s65, v34
    v_dot2c_f32_bf16 v14, s65, v38
    v_dot2c_f32_bf16 v13, s65, v35
    v_dot2c_f32_bf16 v14, s65, v39
    s_waitcnt lgkmcnt(7)
    v_mfma_f32_32x32x16_bf16 v[92:107], v[40:43], v[148:151], v[92:107]
    v_mul_f32 v124, s92, v124
    v_mul_f32 v129, 0xbdd2d3e8, v129
    v_lshlrev_b32 v127, 4, v1
    s_waitcnt lgkmcnt(6)
    v_cvt_pk_bf16_f32 v137, v130, 0
    v_lshlrev_b32 v136, 16, v137
    v_sub_f32 v136, v130, v136
    v_cvt_pk_bf16_f32 v136, v130, v136
    s_nop 1
    v_mfma_f32_32x32x16_bf16 v[44:59], v[136:139], v[16:19], v[44:59]
    s_waitcnt lgkmcnt(5)
    v_cvt_pk_bf16_f32 v137, v131, 0
    v_xor_b32 v11, 2048, v11
    ds_read_b64_tr_b16 v[32:33], v11 offset:0
    ds_read_b64_tr_b16 v[34:35], v11 offset:512
    v_xor_b32 v12, 2048, v12
    ds_read_b64_tr_b16 v[36:37], v12 offset:0
    ds_read_b64_tr_b16 v[38:39], v12 offset:512
    v_mfma_f32_32x32x16_bf16 v[108:123], v[28:31], v[148:151], v[108:123]
    v_lshlrev_b32 v136, 16, v137
    v_sub_f32 v136, v131, v136
    v_cvt_pk_bf16_f32 v136, v131, v136
    s_nop 1
    v_mfma_f32_32x32x16_bf16 v[60:75], v[136:139], v[16:19], v[60:75]
    s_waitcnt lgkmcnt(8)
    v_cvt_pk_bf16_f32 v137, v132, 0
    v_lshlrev_b32 v136, 16, v137
    v_sub_f32 v136, v132, v136
    v_cvt_pk_bf16_f32 v136, v132, v136
    s_nop 1
    v_mfma_f32_32x32x16_bf16 v[76:91], v[136:139], v[16:19], v[76:91]
    s_xor_b32 s82, s67, 3
    s_mul_i32 s82, s82, 2048
    s_lshl_b32 s83, s67, 5
    v_xor_b32 v11, s82, v11
    v_xor_b32 v12, s82, v12
    s_mul_i32 s82, s7, 2
    s_lshl_b32 s83, s6, 3
    s_add_u32 s82, s82, s83
    s_lshl_b32 s82, s82, 7
    s_add_u32 s82, s82, 159744
    v_and_b32 v6, 31, v1
    v_lshlrev_b32 v6, 2, v6
    v_add_u32 v6, s82, v6
    v_mov_b32 v7, v13
    s_nop 1
    v_permlane32_swap_b32 v7, v13
    v_add_f32 v13, v7, v13
    ds_write_b32 v6, v13 offset:0
    v_mov_b32 v7, v14
    s_nop 1
    v_permlane32_swap_b32 v7, v14
    v_add_f32 v14, v7, v14
    ds_write_b32 v6, v14 offset:128
    s_waitcnt vmcnt(7)
    s_waitcnt lgkmcnt(0)
    s_barrier
    v_mfma_f32_32x32x16_bf16 v[92:107], v[20:23], v[152:155], v[92:107]
    s_lshl_b32 s91, s3, 2
    s_add_u32 s91, s91, s6
    s_lshl_b32 s90, s91, 15
    s_add_u32 s93, s93, s90
    s_cmp_ge_u32 s91, 56
    s_cselect_b32 s92, 1376256, 0
    s_lshl_b32 s91, s91, 12
    s_add_u32 s92, s92, s91
    s_add_u32 s92, s92, 22020096
    s_lshr_b32 s90, s4, 1
    s_mul_i32 s90, s90, 229376
    s_add_u32 s91, s92, s90
    s_and_b32 s90, s4, 1
    v_and_b32 v6, 0xff, v0
    v_lshlrev_b32 v6, 2, v6
    ds_read_b64_tr_b16 v[40:41], v11 offset:49152
    ds_read_b64_tr_b16 v[42:43], v11 offset:49664
    v_mfma_f32_32x32x16_bf16 v[108:123], v[24:27], v[152:155], v[108:123]
    s_lshl_b32 s90, s90, 10
    s_add_u32 s91, s91, s90
    s_lshl_b32 s90, s7, 11
    s_add_u32 s91, s91, s90
    s_sub_u32 s94, s4, s94
    s_lshl_b32 s94, s94, 11
    s_lshl_b32 s90, s7, 10
    s_add_u32 s93, s93, s94
    s_add_u32 s93, s93, s90
    v_add_u32 v7, 159744, v6
    ds_read_b64_tr_b16 v[28:29], v12 offset:49152
    ds_read_b64_tr_b16 v[30:31], v12 offset:49664
    v_mfma_f32_32x32x16_bf16 v[92:107], v[32:35], v[156:159], v[92:107]
    v_lshrrev_b32 v130, 5, v1
    v_and_b32 v131, 15, v1
    v_bfe_u32 v4, v1, 4, 1
    v_lshlrev_b32 v131, 4, v131
    v_lshl_add_u32 v131, v4, 14, v131
    v_lshl_add_u32 v131, v130, 8, v131
    v_mul_f32 v44, v124, v44
    v_mul_f32 v45, v124, v45
    v_mul_f32 v46, v124, v46
    ds_read_b32 v140, v7
    ds_read_b32 v141, v7 offset:1024
    ds_read_b64_tr_b16 v[20:21], v11 offset:51200
    ds_read_b64_tr_b16 v[22:23], v11 offset:51712
    v_mfma_f32_32x32x16_bf16 v[108:123], v[36:39], v[156:159], v[108:123]
    v_mul_f32 v47, v124, v47
    v_mul_f32 v48, v124, v48
    v_mul_f32 v49, v124, v49
    v_mul_f32 v50, v124, v50
    v_mul_f32 v51, v124, v51
    v_mul_f32 v52, v124, v52
    v_mul_f32 v53, v124, v53
    v_mul_f32 v54, v124, v54
    v_mul_f32 v55, v124, v55
    ds_read_b32 v142, v7 offset:2048
    ds_read_b64_tr_b16 v[24:25], v12 offset:51200
    ds_read_b64_tr_b16 v[26:27], v12 offset:51712
    s_waitcnt lgkmcnt(7)
    v_mfma_f32_32x32x16_bf16 v[92:107], v[40:43], v[160:163], v[92:107]
    v_mul_f32 v56, v124, v56
    v_mul_f32 v57, v124, v57
    v_mul_f32 v58, v124, v58
    v_mul_f32 v59, v124, v59
    v_cvt_pk_bf16_f32 v44, v44, v45
    v_cvt_pk_bf16_f32 v45, v46, v47
    v_cvt_pk_bf16_f32 v46, v48, v49
    v_cvt_pk_bf16_f32 v47, v50, v51
    s_nop 0
    v_permlane32_swap_b32 v44, v46
    ds_read_b32 v143, v7 offset:3072
    v_lshlrev_b32 v6, 1, v6
    ds_read_b64_tr_b16 v[32:33], v11 offset:53248
    ds_read_b64_tr_b16 v[34:35], v11 offset:53760
    v_mfma_f32_32x32x16_bf16 v[108:123], v[28:31], v[160:163], v[108:123]
    v_permlane32_swap_b32 v45, v47
    buffer_store_dwordx4 v[44:47], v131, s[36:39], s93 offen offset:0 sc1
    v_cvt_pk_bf16_f32 v52, v52, v53
    v_cvt_pk_bf16_f32 v53, v54, v55
    v_cvt_pk_bf16_f32 v54, v56, v57
    v_cvt_pk_bf16_f32 v55, v58, v59
    s_nop 0
    v_permlane32_swap_b32 v52, v54
    v_permlane32_swap_b32 v53, v55
    buffer_store_dwordx4 v[52:55], v131, s[36:39], s93 offen offset:512 sc1
    s_lshl_b32 s82, s4, 5
    s_add_u32 s82, s82, s40
    s_lshl_b32 s82, s82, 11
    s_add_u32 s82, s82, 19955712
    s_cmp_lt_u32 s5, 4
    s_cselect_b32 s82, s82, 0x7ffffff0
    s_waitcnt lgkmcnt(8)
    v_add_f32 v140, v140, v141
    s_waitcnt lgkmcnt(2)
    v_add_f32 v142, v142, v143
    v_mov_b32 v141, s64
    v_add_f32 v140, v140, v142
    buffer_store_dwordx2 v[140:141], v6, s[36:39], s82 offen sc1
    ds_read_b64_tr_b16 v[36:37], v12 offset:53248
    ds_read_b64_tr_b16 v[38:39], v12 offset:53760
    v_mfma_f32_32x32x16_bf16 v[92:107], v[20:23], v[164:167], v[92:107]
    ds_read_b64_tr_b16 v[40:41], v11 offset:55296
    ds_read_b64_tr_b16 v[42:43], v11 offset:55808
    ds_read_b64_tr_b16 v[28:29], v12 offset:55296
    ds_read_b64_tr_b16 v[30:31], v12 offset:55808
    v_mfma_f32_32x32x16_bf16 v[108:123], v[24:27], v[164:167], v[108:123]
    v_mul_f32 v9, v60, v60
    v_mul_f32 v13, v61, v61
    v_mul_f32 v14, v62, v62
    v_mul_f32 v15, v63, v63
    v_mul_f32 v68, v60, v68
    v_mul_f32 v69, v61, v69
    s_waitcnt lgkmcnt(4)
    v_mfma_f32_32x32x16_bf16 v[92:107], v[32:35], v[168:171], v[92:107]
    v_mul_f32 v70, v62, v70
    v_mul_f32 v71, v63, v71
    v_fma_f32 v9, v9, v129, v128
    v_fma_f32 v13, v13, v129, v128
    v_fma_f32 v14, v14, v129, v128
    v_fma_f32 v15, v15, v129, v128
    ds_read_b64_tr_b16 v[20:21], v11 offset:16384
    ds_read_b64_tr_b16 v[22:23], v11 offset:16896
    v_mfma_f32_32x32x16_bf16 v[108:123], v[36:39], v[168:171], v[108:123]
    v_mul_f32 v60, v9, v60
    v_mul_f32 v61, v13, v61
    v_mul_f32 v62, v14, v62
    v_mul_f32 v63, v15, v63
    v_mul_f32 v9, v64, v64
    v_mul_f32 v13, v65, v65
    ds_read_b64_tr_b16 v[24:25], v12 offset:16384
    ds_read_b64_tr_b16 v[26:27], v12 offset:16896
    s_waitcnt lgkmcnt(4)
    v_mfma_f32_32x32x16_bf16 v[92:107], v[40:43], v[172:175], v[92:107]
    v_mul_f32 v14, v66, v66
    v_mul_f32 v15, v67, v67
    v_mul_f32 v72, v64, v72
    v_mul_f32 v73, v65, v73
    v_mul_f32 v74, v66, v74
    ds_read_b64_tr_b16 v[32:33], v11 offset:18432
    ds_read_b64_tr_b16 v[34:35], v11 offset:18944
    v_mfma_f32_32x32x16_bf16 v[108:123], v[28:31], v[172:175], v[108:123]
    v_mul_f32 v75, v67, v75
    v_fma_f32 v9, v9, v129, v128
    v_fma_f32 v13, v13, v129, v128
    v_fma_f32 v14, v14, v129, v128
    v_fma_f32 v15, v15, v129, v128
    v_mul_f32 v64, v9, v64
    ds_read_b64_tr_b16 v[36:37], v12 offset:18432
    ds_read_b64_tr_b16 v[38:39], v12 offset:18944
    s_waitcnt lgkmcnt(4)
    v_mfma_f32_32x32x16_bf16 v[92:107], v[20:23], v[176:179], v[92:107]
    v_mul_f32 v65, v13, v65
    v_mul_f32 v66, v14, v66
    v_mul_f32 v67, v15, v67
    v_exp_f32 v60, v60
    v_exp_f32 v61, v61
    v_exp_f32 v62, v62
    ds_read_b64_tr_b16 v[40:41], v11 offset:20480
    ds_read_b64_tr_b16 v[42:43], v11 offset:20992
    v_mfma_f32_32x32x16_bf16 v[108:123], v[24:27], v[176:179], v[108:123]
    v_exp_f32 v63, v63
    v_exp_f32 v64, v64
    v_exp_f32 v65, v65
    v_exp_f32 v66, v66
    v_exp_f32 v67, v67
    v_fma_f32 v60, v60, v126, v126
    ds_read_b64_tr_b16 v[28:29], v12 offset:20480
    ds_read_b64_tr_b16 v[30:31], v12 offset:20992
    s_waitcnt lgkmcnt(4)
    v_mfma_f32_32x32x16_bf16 v[92:107], v[32:35], v[180:183], v[92:107]
    v_mov_b32 v6, s64
    s_add_u32 s82, s68, 262144
    s_waitcnt vmcnt(1)
    s_mov_b64 exec, 1
    buffer_store_dword v6, off, s[36:39], s82 sc1
    s_mov_b64 exec, -1
    v_fma_f32 v61, v61, v126, v126
    v_fma_f32 v62, v62, v126, v126
    v_fma_f32 v63, v63, v126, v126
    v_fma_f32 v64, v64, v126, v126
    v_fma_f32 v65, v65, v126, v126
    ds_read_b64_tr_b16 v[20:21], v11 offset:22528
    ds_read_b64_tr_b16 v[22:23], v11 offset:23040
    ds_read_b64_tr_b16 v[24:25], v12 offset:22528
    ds_read_b64_tr_b16 v[26:27], v12 offset:23040
    v_mfma_f32_32x32x16_bf16 v[108:123], v[36:39], v[180:183], v[108:123]
    v_fma_f32 v66, v66, v126, v126
    v_fma_f32 v67, v67, v126, v126
    v_rcp_f32 v60, v60
    v_rcp_f32 v61, v61
    v_rcp_f32 v62, v62
    v_rcp_f32 v63, v63
    v_add_u32 v11, 0x10000, v11
    v_add_u32 v12, 0x10000, v12
    s_waitcnt lgkmcnt(0)
    s_barrier
    v_mfma_f32_32x32x16_bf16 v[92:107], v[40:43], v[184:187], v[92:107]
    v_rcp_f32 v64, v64
    v_rcp_f32 v65, v65
    v_rcp_f32 v66, v66
    v_rcp_f32 v67, v67
    v_mul_f32 v68, v68, v60
    v_mul_f32 v69, v69, v61
    ds_read_b64_tr_b16 v[32:33], v11 offset:40960
    ds_read_b64_tr_b16 v[34:35], v11 offset:41472
    v_mfma_f32_32x32x16_bf16 v[108:123], v[28:31], v[184:187], v[108:123]
    v_mul_f32 v70, v70, v62
    v_mul_f32 v71, v71, v63
    v_mul_f32 v72, v72, v64
    v_mul_f32 v73, v73, v65
    v_mul_f32 v74, v74, v66
    v_mul_f32 v75, v75, v67
    ds_read_b64_tr_b16 v[36:37], v12 offset:40960
    ds_read_b64_tr_b16 v[38:39], v12 offset:41472
    v_mfma_f32_32x32x16_bf16 v[92:107], v[20:23], v[188:191], v[92:107]
    v_cvt_pk_bf16_f32 v60, v68, v69
    v_cvt_pk_bf16_f32 v61, v70, v71
    v_cvt_pk_bf16_f32 v62, v72, v73
    v_cvt_pk_bf16_f32 v63, v74, v75
    s_add_u32 s92, s91, 0
    buffer_store_dwordx4 v[60:63], v127, s[36:39], s92 offen sc1
    ds_read_b64_tr_b16 v[40:41], v11 offset:43008
    ds_read_b64_tr_b16 v[42:43], v11 offset:43520
    v_mfma_f32_32x32x16_bf16 v[108:123], v[24:27], v[188:191], v[108:123]
    v_mul_f32 v9, v76, v76
    v_mul_f32 v13, v77, v77
    v_mul_f32 v14, v78, v78
    v_mul_f32 v15, v79, v79
    v_mul_f32 v84, v76, v84
    v_mul_f32 v85, v77, v85
    ds_read_b64_tr_b16 v[28:29], v12 offset:43008
    ds_read_b64_tr_b16 v[30:31], v12 offset:43520
    s_waitcnt lgkmcnt(4)
    v_mfma_f32_32x32x16_bf16 v[92:107], v[32:35], v[192:195], v[92:107]
    v_mul_f32 v86, v78, v86
    v_mul_f32 v87, v79, v87
    v_fma_f32 v9, v9, v129, v128
    v_fma_f32 v13, v13, v129, v128
    v_fma_f32 v14, v14, v129, v128
    v_fma_f32 v15, v15, v129, v128
    ds_read_b64_tr_b16 v[20:21], v11 offset:45056
    ds_read_b64_tr_b16 v[22:23], v11 offset:45568
    v_mfma_f32_32x32x16_bf16 v[108:123], v[36:39], v[192:195], v[108:123]
    v_mul_f32 v76, v9, v76
    v_mul_f32 v77, v13, v77
    v_mul_f32 v78, v14, v78
    v_mul_f32 v79, v15, v79
    v_mul_f32 v9, v80, v80
    v_mul_f32 v13, v81, v81
    ds_read_b64_tr_b16 v[24:25], v12 offset:45056
    ds_read_b64_tr_b16 v[26:27], v12 offset:45568
    s_waitcnt lgkmcnt(4)
    v_mfma_f32_32x32x16_bf16 v[92:107], v[40:43], v[196:199], v[92:107]
    v_mul_f32 v14, v82, v82
    v_mul_f32 v15, v83, v83
    v_mul_f32 v88, v80, v88
    v_mul_f32 v89, v81, v89
    v_mul_f32 v90, v82, v90
    ds_read_b64_tr_b16 v[32:33], v11 offset:47104
    ds_read_b64_tr_b16 v[34:35], v11 offset:47616
    ds_read_b64_tr_b16 v[36:37], v12 offset:47104
    ds_read_b64_tr_b16 v[38:39], v12 offset:47616
    v_mfma_f32_32x32x16_bf16 v[108:123], v[28:31], v[196:199], v[108:123]
    v_mul_f32 v91, v83, v91
    v_fma_f32 v9, v9, v129, v128
    v_fma_f32 v13, v13, v129, v128
    v_fma_f32 v14, v14, v129, v128
    v_fma_f32 v15, v15, v129, v128
    v_mul_f32 v80, v9, v80
    s_waitcnt lgkmcnt(4)
    v_mfma_f32_32x32x16_bf16 v[92:107], v[20:23], v[200:203], v[92:107]
    v_mul_f32 v81, v13, v81
    v_mul_f32 v82, v14, v82
    v_mul_f32 v83, v15, v83
    v_exp_f32 v76, v76
    v_exp_f32 v77, v77
    v_exp_f32 v78, v78
    ds_read_b64_tr_b16 v[40:41], v11 offset:57344
    ds_read_b64_tr_b16 v[42:43], v11 offset:57856
    v_mfma_f32_32x32x16_bf16 v[108:123], v[24:27], v[200:203], v[108:123]
    v_exp_f32 v79, v79
    v_exp_f32 v80, v80
    v_exp_f32 v81, v81
    v_exp_f32 v82, v82
    v_exp_f32 v83, v83
    v_fma_f32 v76, v76, v126, v126
    ds_read_b64_tr_b16 v[28:29], v12 offset:57344
    ds_read_b64_tr_b16 v[30:31], v12 offset:57856
    s_waitcnt lgkmcnt(4)
    v_mfma_f32_32x32x16_bf16 v[92:107], v[32:35], v[204:207], v[92:107]
    v_fma_f32 v77, v77, v126, v126
    v_fma_f32 v78, v78, v126, v126
    v_fma_f32 v79, v79, v126, v126
    v_fma_f32 v80, v80, v126, v126
    v_fma_f32 v81, v81, v126, v126
    ds_read_b64_tr_b16 v[20:21], v11 offset:59392
    ds_read_b64_tr_b16 v[22:23], v11 offset:59904
    v_mfma_f32_32x32x16_bf16 v[108:123], v[36:39], v[204:207], v[108:123]
    v_fma_f32 v82, v82, v126, v126
    v_fma_f32 v83, v83, v126, v126
    v_rcp_f32 v76, v76
    v_rcp_f32 v77, v77
    v_rcp_f32 v78, v78
    v_rcp_f32 v79, v79
    ds_read_b64_tr_b16 v[24:25], v12 offset:59392
    ds_read_b64_tr_b16 v[26:27], v12 offset:59904
    s_waitcnt lgkmcnt(4)
    v_mfma_f32_32x32x16_bf16 v[92:107], v[40:43], v[208:211], v[92:107]
    v_rcp_f32 v80, v80
    v_rcp_f32 v81, v81
    v_rcp_f32 v82, v82
    v_rcp_f32 v83, v83
    v_mul_f32 v84, v84, v76
    v_mul_f32 v85, v85, v77
    s_mul_i32 s82, s5, 3
    s_lshl_b32 s83, s3, 3
    s_add_u32 s82, s82, s83
    s_sub_i32 s82, s82, 16
    s_ashr_i32 s82, s82, 1
    s_lshl_b32 s83, s3, 2
    s_lshr_b32 s84, s5, 1
    s_add_u32 s83, s83, s84
    s_lshr_b32 s84, s4, 1
    s_mul_i32 s84, s84, 7
    s_bitcmp1_b32 s4, 0
    s_cselect_b32 s85, 3, 0
    s_add_u32 s84, s84, s85
    s_add_u32 s85, s84, 3
    s_lshr_b32 s84, s84, 3
    s_lshr_b32 s85, s85, 3
    s_sub_u32 s85, s85, s84
    s_lshr_b32 s86, s4, 3
    s_lshl_b32 s86, s86, 5
    s_add_u32 s86, s86, 262592
    v_bfe_u32 v6, v1, 2, 1
    v_add_u32 v6, s82, v6
    v_max_i32 v6, 0, v6
    v_mov_b32 v7, s83
    v_and_b32 v8, 8, v1
    v_cmp_ne_u32 vcc, 0, v8
    v_and_b32 v8, 1, v1
    v_mul_u32_u24 v8, s85, v8
    v_add_u32 v8, s84, v8
    v_lshlrev_b32 v61, 9, v6
    v_cndmask_b32 v6, v6, v7, vcc
    v_add_u32 v7, 7, v8
    v_add_u32 v61, s86, v61
    v_cndmask_b32 v8, v7, v8, vcc
    v_lshlrev_b32 v6, 9, v6
    v_lshl_add_u32 v6, v8, 5, v6
    v_add_u32 v60, 262144, v6
    ds_read_b64_tr_b16 v[32:33], v11 offset:61440
    ds_read_b64_tr_b16 v[34:35], v11 offset:61952
    v_mfma_f32_32x32x16_bf16 v[108:123], v[28:31], v[208:211], v[108:123]
    v_mul_f32 v86, v86, v78
    v_mul_f32 v87, v87, v79
    v_mul_f32 v88, v88, v80
    v_mul_f32 v89, v89, v81
    v_mul_f32 v90, v90, v82
    v_mul_f32 v91, v91, v83
    ds_read_b64_tr_b16 v[36:37], v12 offset:61440
    ds_read_b64_tr_b16 v[38:39], v12 offset:61952
    s_waitcnt lgkmcnt(4)
    v_mfma_f32_32x32x16_bf16 v[92:107], v[20:23], v[212:215], v[92:107]
    v_cvt_pk_bf16_f32 v76, v84, v85
    v_cvt_pk_bf16_f32 v77, v86, v87
    v_cvt_pk_bf16_f32 v78, v88, v89
    v_cvt_pk_bf16_f32 v79, v90, v91
    s_add_u32 s92, s91, 3211264
    buffer_store_dwordx4 v[76:79], v127, s[36:39], s92 offen sc1
    ds_read_b64_tr_b16 v[40:41], v11 offset:63488
    ds_read_b64_tr_b16 v[42:43], v11 offset:64000
    ds_read_b64_tr_b16 v[28:29], v12 offset:63488
    ds_read_b64_tr_b16 v[30:31], v12 offset:64000
    v_mfma_f32_32x32x16_bf16 v[108:123], v[24:27], v[212:215], v[108:123]
    s_add_u32 m0, s66, 49152
    s_add_u32 s82, s56, 0
    buffer_load_dwordx4 v3, s[24:27], s82 offen lds
    s_waitcnt lgkmcnt(4)
    v_mfma_f32_32x32x16_bf16 v[92:107], v[32:35], v[216:219], v[92:107]
    s_lshl_b32 s82, s77, 1
    s_add_u32 s82, s82, s7
    s_lshl_b32 s84, s82, 9
    s_add_u32 s84, s84, 393216
    v_bfe_u32 v150, v1, 1, 3
    v_min_u32 v150, 6, v150
    v_add_u32 v150, s79, v150
    v_subrev_u32 v151, 7, v150
    v_min_u32 v150, v150, v151
    v_and_b32 v151, 1, v1
    v_lshl_add_u32 v150, v150, 1, v151
    v_lshlrev_b32 v150, 5, v150
    v_add_u32 v150, s84, v150
    v_add_u32 v151, 131072, v150
    v_lshlrev_b32 v75, 4, v1
    ds_read_b64_tr_b16 v[20:21], v11 offset:0
    ds_read_b64_tr_b16 v[22:23], v11 offset:512
    v_mfma_f32_32x32x16_bf16 v[108:123], v[36:39], v[216:219], v[108:123]
    s_add_u32 m0, s66, 57344
    s_add_u32 s82, s56, 114688
    buffer_load_dwordx4 v3, s[24:27], s82 offen lds
    v_mov_b32 v72, 0xf149f2ca
    s_and_b32 s82, s5, 6
    s_lshl_b32 s82, s82, 10
    v_add_u32 v148, s82, v75
    s_bitcmp1_b32 s5, 0
    s_cselect_b64 s[20:21], -1, 0
    v_add_u32 v149, 24576, v148
    ds_read_b64_tr_b16 v[24:25], v12 offset:0
    ds_read_b64_tr_b16 v[26:27], v12 offset:512
    s_waitcnt lgkmcnt(4)
    v_mfma_f32_32x32x16_bf16 v[92:107], v[40:43], v[220:223], v[92:107]
    v_lshrrev_b32 v64, 4, v1
    v_and_b32 v65, 15, v1
    ds_read_b64_tr_b16 v[32:33], v11 offset:2048
    ds_read_b64_tr_b16 v[34:35], v11 offset:2560
    v_mfma_f32_32x32x16_bf16 v[108:123], v[28:31], v[220:223], v[108:123]
    s_add_u32 m0, s66, 65536
    s_add_u32 s82, s57, 0
    buffer_load_dwordx4 v3, s[24:27], s82 offen lds
    v_lshlrev_b32 v66, 2, v64
    v_sub_u32 v66, v66, v65
    v_lshrrev_b32 v67, 2, v65
    ds_read_b64_tr_b16 v[36:37], v12 offset:2048
    ds_read_b64_tr_b16 v[38:39], v12 offset:2560
    s_waitcnt lgkmcnt(4)
    v_mfma_f32_32x32x16_bf16 v[92:107], v[20:23], v[224:227], v[92:107]
    v_lshlrev_b32 v57, 1, v67
    v_add_u32 v57, 12, v57
    s_cmp_ge_u32 s5, 2
    s_cbranch_scc1 csi_6
    v_lshlrev_b32 v2, 3, v0
    s_lshl_b32 s96, s4, 16
    s_add_u32 s96, s96, 19955712
    s_add_u32 s97, s96, 4096
    s_add_u32 s98, s96, 8192
    s_add_u32 s99, s96, 12288
    buffer_load_dwordx2 v[130:131], v2, s[36:39], s96 offen offset:0 sc1
    buffer_load_dwordx2 v[132:133], v2, s[36:39], s96 offen offset:2048 sc1
    buffer_load_dwordx2 v[134:135], v2, s[36:39], s97 offen offset:0 sc1
    buffer_load_dwordx2 v[136:137], v2, s[36:39], s97 offen offset:2048 sc1
    buffer_load_dwordx2 v[138:139], v2, s[36:39], s98 offen offset:0 sc1
    buffer_load_dwordx2 v[140:141], v2, s[36:39], s98 offen offset:2048 sc1
    buffer_load_dwordx2 v[142:143], v2, s[36:39], s99 offen offset:0 sc1
csi_6:
    ds_read_b64_tr_b16 v[40:41], v11 offset:4096
    ds_read_b64_tr_b16 v[42:43], v11 offset:4608
    v_mfma_f32_32x32x16_bf16 v[108:123], v[24:27], v[224:227], v[108:123]
    s_add_u32 m0, s66, 73728
    s_add_u32 s82, s57, 114688
    buffer_load_dwordx4 v3, s[24:27], s82 offen lds
    v_sub_u32 v57, v57, v65
    v_and_b32 v56, 3, v1
    v_cmp_eq_u32 vcc, 3, v56
    s_nop 1
    v_cndmask_b32 v57, 0, v57, vcc
    v_sub_u32 v57, v57, v67
    ds_read_b64_tr_b16 v[28:29], v12 offset:4096
    ds_read_b64_tr_b16 v[30:31], v12 offset:4608
    s_waitcnt lgkmcnt(4)
    v_mfma_f32_32x32x16_bf16 v[92:107], v[32:35], v[228:231], v[92:107]
    v_lshl_add_u32 v57, v57, 4, v149
    v_cmp_ge_i32 s[12:13], 0, v66
    v_cmp_ge_i32 s[14:15], -1, v66
    ds_read_b64_tr_b16 v[20:21], v11 offset:6144
    ds_read_b64_tr_b16 v[22:23], v11 offset:6656
    ds_read_b64_tr_b16 v[24:25], v12 offset:6144
    ds_read_b64_tr_b16 v[26:27], v12 offset:6656
    v_mfma_f32_32x32x16_bf16 v[108:123], v[36:39], v[228:231], v[108:123]
    v_cmp_ge_i32 s[16:17], -2, v66
    v_cmp_ge_i32 s[18:19], -3, v66
    s_waitcnt lgkmcnt(4)
    v_mfma_f32_32x32x16_bf16 v[92:107], v[40:43], v[232:235], v[92:107]
    buffer_load_dwordx2 v[62:63], v60, s[36:39], 0 offen sc1
    v_lshlrev_b32 v65, 4, v65
    v_lshl_add_u32 v56, v64, 9, v65
    s_lshl_b32 s82, s3, 2
    s_lshr_b32 s83, s5, 1
    s_add_u32 s82, s82, s83
    s_mul_i32 s82, s82, 32768
    s_and_b32 s83, s5, 1
    s_lshl_b32 s83, s83, 8
    s_add_u32 s82, s82, s83
    s_add_u32 s82, s82, 16777216
    s_lshl_b32 s83, s4, 11
    s_add_u32 s75, s82, s83
    s_and_b32 s76, s64, 0xffff0000
    ds_read_b64_tr_b16 v[32:33], v11 offset:24576
    ds_read_b64_tr_b16 v[34:35], v11 offset:25088
    v_mfma_f32_32x32x16_bf16 v[108:123], v[28:31], v[232:235], v[108:123]
    v_bfe_u32 v64, v1, 2, 2
    v_lshrrev_b32 v65, 5, v1
    ds_read_b64_tr_b16 v[36:37], v12 offset:24576
    ds_read_b64_tr_b16 v[38:39], v12 offset:25088
    s_waitcnt lgkmcnt(4)
    v_mfma_f32_32x32x16_bf16 v[92:107], v[20:23], v[236:239], v[92:107]
    v_lshl_add_u32 v66, v65, 2, v64
    v_lshlrev_b32 v66, 7, v66
    v_and_b32 v67, 3, v1
    ds_read_b64_tr_b16 v[40:41], v11 offset:26624
    ds_read_b64_tr_b16 v[42:43], v11 offset:27136
    v_mfma_f32_32x32x16_bf16 v[108:123], v[24:27], v[236:239], v[108:123]
    v_lshlrev_b32 v67, 3, v67
    v_bfe_u32 v55, v1, 4, 1
    v_lshl_add_u32 v67, v55, 5, v67
    ds_read_b64_tr_b16 v[28:29], v12 offset:26624
    ds_read_b64_tr_b16 v[30:31], v12 offset:27136
    s_waitcnt lgkmcnt(4)
    v_mfma_f32_32x32x16_bf16 v[92:107], v[32:35], v[240:243], v[92:107]
    v_add_u32 v66, v66, v67
    v_bfe_u32 v55, v1, 3, 1
    ds_read_b64_tr_b16 v[20:21], v11 offset:28672
    ds_read_b64_tr_b16 v[22:23], v11 offset:29184
    v_mfma_f32_32x32x16_bf16 v[108:123], v[36:39], v[240:243], v[108:123]
    v_lshl_add_u32 v66, v55, 6, v66
    s_lshl_b32 s82, s6, 11
    s_add_u32 s82, s82, 49152
    v_add_u32 v44, s82, v66
    v_xor_b32 v45, 64, v44
    ds_read_b64_tr_b16 v[24:25], v12 offset:28672
    ds_read_b64_tr_b16 v[26:27], v12 offset:29184
    s_waitcnt lgkmcnt(4)
    v_mfma_f32_32x32x16_bf16 v[92:107], v[40:43], v[244:247], v[92:107]
    v_mov_b32 v46, v66
    v_mov_b32 v50, v67
    ds_read_b64_tr_b16 v[32:33], v11 offset:30720
    ds_read_b64_tr_b16 v[34:35], v11 offset:31232
    ds_read_b64_tr_b16 v[36:37], v12 offset:30720
    ds_read_b64_tr_b16 v[38:39], v12 offset:31232
    v_mfma_f32_32x32x16_bf16 v[108:123], v[28:31], v[244:247], v[108:123]
    s_waitcnt lgkmcnt(4)
    v_mfma_f32_32x32x16_bf16 v[92:107], v[20:23], v[248:251], v[92:107]
    s_cmp_ge_u32 s5, 2
    s_waitcnt vmcnt(2)
    s_cbranch_scc1 csf_7
    v_xor_b32 v6, s64, v131
    v_mov_b32 v7, s64
    v_bitop3_b32 v6, v133, v7, v6 bitop3:0xbe
    v_bitop3_b32 v6, v135, v7, v6 bitop3:0xbe
    v_bitop3_b32 v6, v137, v7, v6 bitop3:0xbe
    v_bitop3_b32 v6, v139, v7, v6 bitop3:0xbe
    v_bitop3_b32 v6, v141, v7, v6 bitop3:0xbe
    v_bitop3_b32 v6, v143, v7, v6 bitop3:0xbe
    v_cmp_ne_u32 vcc, 0, v6
    s_cbranch_vccnz chk_8_slow
chk_8_back:
    v_add_f32 v130, v130, v132
    v_add_f32 v134, v134, v136
    v_add_f32 v138, v138, v140
    v_add_f32 v130, v130, v142
    v_add_f32 v134, v134, v138
    v_lshrrev_b32 v6, 1, v2
    v_add_u32 v6, 156416, v6
    v_add_f32 v130, v130, v134
    ds_write_b32 v6, v130
csf_7:
    v_mfma_f32_32x32x16_bf16 v[108:123], v[24:27], v[248:251], v[108:123]
    s_waitcnt lgkmcnt(0)
    v_mfma_f32_32x32x16_bf16 v[92:107], v[32:35], v[252:255], v[92:107]
    v_mfma_f32_32x32x16_bf16 v[108:123], v[36:39], v[252:255], v[108:123]
    s_barrier
    ds_read_b32 v130, v10
    ds_read_b32 v131, v10 offset:128
    v_mov_b32 v138, 0
    v_mov_b32 v139, 0
    v_mov_b32 v6, s64
    s_add_u32 s82, s68, 393216
    s_mov_b64 exec, 1
    buffer_store_dword v6, off, s[36:39], s82 sc1
    s_mov_b64 exec, -1
    s_waitcnt lgkmcnt(1)
    v_cvt_pk_bf16_f32 v137, v130, 0
    v_lshlrev_b32 v136, 16, v137
    v_sub_f32 v136, v130, v136
    v_cvt_pk_bf16_f32 v136, v130, v136
    s_nop 1
    v_mfma_f32_32x32x16_bf16 v[92:107], v[136:139], v[16:19], v[92:107]
    s_waitcnt lgkmcnt(0)
    v_cvt_pk_bf16_f32 v137, v131, 0
    v_lshlrev_b32 v136, 16, v137
    v_sub_f32 v136, v131, v136
    v_cvt_pk_bf16_f32 v136, v131, v136
    s_nop 1
    v_mfma_f32_32x32x16_bf16 v[108:123], v[136:139], v[16:19], v[108:123]
    s_nop 3
    v_mul_f32 v76, v92, v92
    v_mul_f32 v77, v93, v93
    v_mul_f32 v78, v94, v94
    v_mul_f32 v79, v95, v95
    v_mul_f32 v80, v96, v96
    s_waitcnt vmcnt(1)
    v_mov_b32 v6, v62
    v_mul_f32 v81, v97, v97
    v_mul_f32 v82, v98, v98
    v_mul_f32 v83, v99, v99
    v_mul_f32 v100, v92, v100
    s_add_u32 m0, s101, 0
    s_nop 0
    buffer_load_dwordx4 v75, s[36:39], s0 offen sc1 lds
    v_mul_f32 v101, v93, v101
    v_mul_f32 v102, v94, v102
    v_mul_f32 v103, v95, v103
    v_mul_f32 v104, v96, v104
    s_add_u32 m0, s101, 1024
    s_nop 0
    buffer_load_dwordx4 v75, s[36:39], s1 offen sc1 lds
    v_mul_f32 v105, v97, v105
    v_mul_f32 v106, v98, v106
    v_mul_f32 v107, v99, v107
    v_fma_f32 v76, v76, v129, v128
    s_add_u32 m0, s101, 2048
    s_nop 0
    buffer_load_dwordx4 v75, s[36:39], s69 offen sc1 lds
    v_fma_f32 v77, v77, v129, v128
    v_fma_f32 v78, v78, v129, v128
    v_fma_f32 v79, v79, v129, v128
    v_fma_f32 v80, v80, v129, v128
    buffer_load_dwordx4 v[68:71], v75, s[36:39], s42 offen sc1
    v_fma_f32 v81, v81, v129, v128
    v_fma_f32 v82, v82, v129, v128
    v_fma_f32 v83, v83, v129, v128
    v_mul_f32 v92, v76, v92
    v_mul_f32 v93, v77, v93
    v_mul_f32 v94, v78, v94
    v_mul_f32 v95, v79, v95
    v_mul_f32 v96, v80, v96
    v_mul_f32 v97, v81, v97
    v_mul_f32 v98, v82, v98
    v_mul_f32 v99, v83, v99
    v_exp_f32 v92, v92
    v_exp_f32 v93, v93
    v_exp_f32 v94, v94
    v_exp_f32 v95, v95
    v_exp_f32 v96, v96
    v_exp_f32 v97, v97
    v_exp_f32 v98, v98
    v_exp_f32 v99, v99
    v_fma_f32 v92, v92, v126, v126
    v_fma_f32 v93, v93, v126, v126
    v_fma_f32 v94, v94, v126, v126
    v_fma_f32 v95, v95, v126, v126
    v_fma_f32 v96, v96, v126, v126
    v_fma_f32 v97, v97, v126, v126
    v_fma_f32 v98, v98, v126, v126
    v_fma_f32 v99, v99, v126, v126
    v_rcp_f32 v92, v92
    v_rcp_f32 v93, v93
    v_rcp_f32 v94, v94
    v_rcp_f32 v95, v95
    v_rcp_f32 v96, v96
    v_rcp_f32 v97, v97
    v_rcp_f32 v98, v98
    v_rcp_f32 v99, v99
    v_mul_f32 v100, v100, v92
    v_mul_f32 v101, v101, v93
    v_mul_f32 v102, v102, v94
    v_mul_f32 v103, v103, v95
    v_mul_f32 v104, v104, v96
    v_mul_f32 v105, v105, v97
    v_mul_f32 v106, v106, v98
    v_mul_f32 v107, v107, v99
    v_cvt_pk_bf16_f32 v92, v100, v101
    v_cvt_pk_bf16_f32 v93, v102, v103
    v_cvt_pk_bf16_f32 v94, v104, v105
    v_cvt_pk_bf16_f32 v95, v106, v107
    s_add_u32 s92, s91, 6422528
    buffer_store_dwordx4 v[92:95], v127, s[36:39], s92 offen sc1
    v_mul_f32 v76, v108, v108
    v_mul_f32 v77, v109, v109
    v_mul_f32 v78, v110, v110
    v_mul_f32 v79, v111, v111
    v_mul_f32 v80, v112, v112
    v_mul_f32 v81, v113, v113
    v_mul_f32 v82, v114, v114
    v_mul_f32 v83, v115, v115
    v_mul_f32 v116, v108, v116
    v_mul_f32 v117, v109, v117
    v_mul_f32 v118, v110, v118
    v_mul_f32 v119, v111, v119
    v_mul_f32 v120, v112, v120
    v_mul_f32 v121, v113, v121
    v_mul_f32 v122, v114, v122
    v_mul_f32 v123, v115, v123
    v_fma_f32 v76, v76, v129, v128
    v_fma_f32 v77, v77, v129, v128
    v_fma_f32 v78, v78, v129, v128
    v_fma_f32 v79, v79, v129, v128
    v_fma_f32 v80, v80, v129, v128
    v_fma_f32 v81, v81, v129, v128
    s_add_u32 m0, s66, 81920
    s_add_u32 s82, s58, 0
    buffer_load_dwordx4 v3, s[24:27], s82 offen lds
    v_fma_f32 v82, v82, v129, v128
    v_fma_f32 v83, v83, v129, v128
    v_mul_f32 v108, v76, v108
    v_mul_f32 v109, v77, v109
    v_mul_f32 v110, v78, v110
    v_mul_f32 v111, v79, v111
    v_mul_f32 v112, v80, v112
    v_mul_f32 v113, v81, v113
    v_mul_f32 v114, v82, v114
    v_mul_f32 v115, v83, v115
    v_exp_f32 v108, v108
    v_exp_f32 v109, v109
    v_exp_f32 v110, v110
    v_exp_f32 v111, v111
    v_exp_f32 v112, v112
    v_exp_f32 v113, v113
    v_exp_f32 v114, v114
    v_exp_f32 v115, v115
    v_fma_f32 v108, v108, v126, v126
    v_fma_f32 v109, v109, v126, v126
    s_add_u32 m0, s66, 90112
    s_add_u32 s82, s58, 114688
    buffer_load_dwordx4 v3, s[24:27], s82 offen lds
    v_fma_f32 v110, v110, v126, v126
    v_fma_f32 v111, v111, v126, v126
    v_fma_f32 v112, v112, v126, v126
    v_fma_f32 v113, v113, v126, v126
    v_fma_f32 v114, v114, v126, v126
    v_fma_f32 v115, v115, v126, v126
    v_rcp_f32 v108, v108
    v_rcp_f32 v109, v109
    v_rcp_f32 v110, v110
    v_rcp_f32 v111, v111
    v_rcp_f32 v112, v112
    v_rcp_f32 v113, v113
    v_rcp_f32 v114, v114
    v_rcp_f32 v115, v115
    v_mul_f32 v116, v116, v108
    v_mul_f32 v117, v117, v109
    v_mul_f32 v118, v118, v110
    v_mul_f32 v119, v119, v111
    v_mul_f32 v120, v120, v112
    v_mul_f32 v121, v121, v113
    v_mul_f32 v122, v122, v114
    v_mul_f32 v123, v123, v115
    v_cvt_pk_bf16_f32 v108, v116, v117
    v_cvt_pk_bf16_f32 v109, v118, v119
    v_cvt_pk_bf16_f32 v110, v120, v121
    v_cvt_pk_bf16_f32 v111, v122, v123
    s_add_u32 s92, s91, 9633792
    buffer_store_dwordx4 v[108:111], v127, s[36:39], s92 offen sc1
    v_xor_b32 v6, s64, v62
    v_mov_b32 v7, s64
    v_bitop3_b32 v6, v63, v7, v6 bitop3:0xbe
    v_cmp_ne_u32 vcc, 0, v6
    s_cbranch_vccnz chk_9_slow
chk_9_back:
    s_waitcnt vmcnt(4)
    s_barrier
    s_nop 11
L_att:
    ds_read_b128 v[4:7], v148 offset:0
    ds_read_b128 v[8:11], v148 offset:1024
    ds_read_b128 v[12:15], v148 offset:2048
    v_cmp_le_u32 s[82:83], 48, v1
    s_bitcmp1_b32 s4, 0
    s_cselect_b64 s[84:85], 0xffff, 0
    s_cselect_b64 s[82:83], 0, s[82:83]
    v_cndmask_b32 v68, v68, 0, s[84:85]
    v_cndmask_b32 v69, v69, 0, s[84:85]
    v_cndmask_b32 v70, v70, 0, s[82:83]
    v_cndmask_b32 v71, v71, 0, s[82:83]
    ds_read_b128 v[16:19], v148 offset:3072
    s_waitcnt lgkmcnt(3)
    v_mfma_f32_16x16x32_bf16 v[76:79], v[4:7], v[68:71], 0
    ds_read_b128 v[4:7], v148 offset:4096
    s_waitcnt lgkmcnt(3)
    v_mfma_f32_16x16x32_bf16 v[80:83], v[8:11], v[68:71], 0
    ds_read_b128 v[8:11], v148 offset:5120
    s_waitcnt lgkmcnt(3)
    v_mfma_f32_16x16x32_bf16 v[84:87], v[12:15], v[68:71], 0
    ds_read_b128 v[12:15], v148 offset:6144
    s_waitcnt lgkmcnt(3)
    v_mfma_f32_16x16x32_bf16 v[88:91], v[16:19], v[68:71], 0
    s_add_u32 m0, s66, 98304
    s_add_u32 s82, s59, 0
    buffer_load_dwordx4 v3, s[24:27], s82 offen lds
    ds_read_b128 v[16:19], v148 offset:7168
    s_waitcnt lgkmcnt(3)
    v_mfma_f32_16x16x32_bf16 v[92:95], v[4:7], v[68:71], 0
    s_nor_b64 s[22:23], s[12:13], s[20:21]
    v_cndmask_b32 v76, v72, v76, s[22:23]
    s_nor_b64 s[86:87], s[14:15], s[20:21]
    v_cndmask_b32 v77, v72, v77, s[86:87]
    s_nor_b64 s[22:23], s[16:17], s[20:21]
    v_cndmask_b32 v78, v72, v78, s[22:23]
    s_nor_b64 s[86:87], s[18:19], s[20:21]
    v_cndmask_b32 v79, v72, v79, s[86:87]
    v_max_f32 v73, v76, v77
    v_max_f32 v74, v78, v79
    ds_read_b128 v[4:7], v148 offset:8192
    s_waitcnt lgkmcnt(3)
    v_mfma_f32_16x16x32_bf16 v[96:99], v[8:11], v[68:71], 0
    s_nand_b64 s[22:23], s[12:13], s[20:21]
    v_cndmask_b32 v80, v72, v80, s[22:23]
    s_nand_b64 s[86:87], s[14:15], s[20:21]
    v_cndmask_b32 v81, v72, v81, s[86:87]
    s_nand_b64 s[22:23], s[16:17], s[20:21]
    v_cndmask_b32 v82, v72, v82, s[22:23]
    s_nand_b64 s[86:87], s[18:19], s[20:21]
    v_cndmask_b32 v83, v72, v83, s[86:87]
    v_max3_f32 v73, v73, v80, v81
    v_max3_f32 v74, v74, v82, v83
    ds_read_b128 v[8:11], v148 offset:9216
    s_waitcnt lgkmcnt(3)
    v_mfma_f32_16x16x32_bf16 v[100:103], v[12:15], v[68:71], 0
    v_max3_f32 v73, v73, v84, v85
    v_max3_f32 v74, v74, v86, v87
    ds_read_b128 v[12:15], v148 offset:10240
    s_waitcnt lgkmcnt(3)
    v_mfma_f32_16x16x32_bf16 v[104:107], v[16:19], v[68:71], 0
    s_add_u32 m0, s66, 106496
    s_add_u32 s82, s59, 114688
    buffer_load_dwordx4 v3, s[24:27], s82 offen lds
    v_max3_f32 v73, v73, v88, v89
    v_max3_f32 v74, v74, v90, v91
    ds_read_b128 v[16:19], v148 offset:11264
    s_waitcnt lgkmcnt(3)
    v_mfma_f32_16x16x32_bf16 v[108:111], v[4:7], v[68:71], 0
    v_max3_f32 v73, v73, v92, v93
    v_max3_f32 v74, v74, v94, v95
    ds_read_b128 v[4:7], v148 offset:12288
    s_waitcnt lgkmcnt(3)
    v_mfma_f32_16x16x32_bf16 v[112:115], v[8:11], v[68:71], 0
    v_max3_f32 v73, v73, v96, v97
    v_max3_f32 v74, v74, v98, v99
    ds_read_b128 v[8:11], v148 offset:13312
    s_waitcnt lgkmcnt(3)
    v_mfma_f32_16x16x32_bf16 v[116:119], v[12:15], v[68:71], 0
    v_max3_f32 v73, v73, v100, v101
    v_max3_f32 v74, v74, v102, v103
    ds_read_b128 v[12:15], v148 offset:14336
    s_waitcnt lgkmcnt(3)
    v_mfma_f32_16x16x32_bf16 v[120:123], v[16:19], v[68:71], 0
    s_add_u32 m0, s66, 122880
    s_add_u32 s82, s60, 0
    buffer_load_dwordx4 v3, s[24:27], s82 offen lds
    v_max3_f32 v73, v73, v104, v105
    v_max3_f32 v74, v74, v106, v107
    ds_read_b128 v[16:19], v148 offset:15360
    s_waitcnt lgkmcnt(3)
    v_mfma_f32_16x16x32_bf16 v[124:127], v[4:7], v[68:71], 0
    v_max3_f32 v73, v73, v108, v109
    v_max3_f32 v74, v74, v110, v111
    ds_read_b128 v[4:7], v148 offset:16384
    s_waitcnt lgkmcnt(3)
    v_mfma_f32_16x16x32_bf16 v[128:131], v[8:11], v[68:71], 0
    v_max3_f32 v73, v73, v112, v113
    v_max3_f32 v74, v74, v114, v115
    ds_read_b128 v[8:11], v148 offset:17408
    s_waitcnt lgkmcnt(3)
    v_mfma_f32_16x16x32_bf16 v[132:135], v[12:15], v[68:71], 0
    v_max3_f32 v73, v73, v116, v117
    v_max3_f32 v74, v74, v118, v119
    s_waitcnt lgkmcnt(2)
    v_mfma_f32_16x16x32_bf16 v[136:139], v[16:19], v[68:71], 0
    s_add_u32 m0, s66, 131072
    s_add_u32 s82, s60, 114688
    buffer_load_dwordx4 v3, s[24:27], s82 offen lds
    v_max3_f32 v73, v73, v120, v121
    v_max3_f32 v74, v74, v122, v123
    s_waitcnt lgkmcnt(1)
    v_mfma_f32_16x16x32_bf16 v[140:143], v[4:7], v[68:71], 0
    v_max3_f32 v73, v73, v124, v125
    v_max3_f32 v74, v74, v126, v127
    s_waitcnt lgkmcnt(0)
    v_mfma_f32_16x16x32_bf16 v[144:147], v[8:11], v[68:71], 0
    v_max3_f32 v73, v73, v128, v129
    v_max3_f32 v74, v74, v130, v131
    v_max3_f32 v73, v73, v132, v133
    v_max3_f32 v74, v74, v134, v135
    v_max3_f32 v73, v73, v136, v137
    v_max3_f32 v74, v74, v138, v139
    s_or_b64 s[22:23], s[12:13], s[20:21]
    v_cndmask_b32 v140, v72, v140, s[22:23]
    s_or_b64 s[86:87], s[14:15], s[20:21]
    v_cndmask_b32 v141, v72, v141, s[86:87]
    s_or_b64 s[22:23], s[16:17], s[20:21]
    v_cndmask_b32 v142, v72, v142, s[22:23]
    s_or_b64 s[86:87], s[18:19], s[20:21]
    v_cndmask_b32 v143, v72, v143, s[86:87]
    v_max3_f32 v73, v73, v140, v141
    v_max3_f32 v74, v74, v142, v143
    s_and_b64 s[22:23], s[12:13], s[20:21]
    v_cndmask_b32 v144, v72, v144, s[22:23]
    s_and_b64 s[86:87], s[14:15], s[20:21]
    v_cndmask_b32 v145, v72, v145, s[86:87]
    s_and_b64 s[22:23], s[16:17], s[20:21]
    v_cndmask_b32 v146, v72, v146, s[22:23]
    s_and_b64 s[86:87], s[18:19], s[20:21]
    v_cndmask_b32 v147, v72, v147, s[86:87]
    v_max3_f32 v73, v73, v144, v145
    v_max3_f32 v74, v74, v146, v147
    s_cmp_lt_u32 s3, 2
    s_cbranch_scc0 rare_44
    s_lshl_b32 s82, s3, 3
    s_and_b32 s83, s5, 6
    s_add_u32 s82, s82, s83
    s_sub_i32 s82, 16, s82
    s_cmp_gt_i32 s82, 0
    s_cselect_b64 s[22:23], 0, -1
    v_cndmask_b32 v76, v72, v76, s[22:23]
    v_cndmask_b32 v77, v72, v77, s[22:23]
    v_cndmask_b32 v78, v72, v78, s[22:23]
    v_cndmask_b32 v79, v72, v79, s[22:23]
    s_cmp_gt_i32 s82, 1
    s_cselect_b64 s[86:87], 0, -1
    v_cndmask_b32 v80, v72, v80, s[86:87]
    v_cndmask_b32 v81, v72, v81, s[86:87]
    v_cndmask_b32 v82, v72, v82, s[86:87]
    v_cndmask_b32 v83, v72, v83, s[86:87]
    s_cmp_gt_i32 s82, 2
    s_cselect_b64 s[22:23], 0, -1
    v_cndmask_b32 v84, v72, v84, s[22:23]
    v_cndmask_b32 v85, v72, v85, s[22:23]
    v_cndmask_b32 v86, v72, v86, s[22:23]
    v_cndmask_b32 v87, v72, v87, s[22:23]
    s_cmp_gt_i32 s82, 3
    s_cselect_b64 s[86:87], 0, -1
    v_cndmask_b32 v88, v72, v88, s[86:87]
    v_cndmask_b32 v89, v72, v89, s[86:87]
    v_cndmask_b32 v90, v72, v90, s[86:87]
    v_cndmask_b32 v91, v72, v91, s[86:87]
    s_cmp_gt_i32 s82, 4
    s_cselect_b64 s[22:23], 0, -1
    v_cndmask_b32 v92, v72, v92, s[22:23]
    v_cndmask_b32 v93, v72, v93, s[22:23]
    v_cndmask_b32 v94, v72, v94, s[22:23]
    v_cndmask_b32 v95, v72, v95, s[22:23]
    s_cmp_gt_i32 s82, 5
    s_cselect_b64 s[86:87], 0, -1
    v_cndmask_b32 v96, v72, v96, s[86:87]
    v_cndmask_b32 v97, v72, v97, s[86:87]
    v_cndmask_b32 v98, v72, v98, s[86:87]
    v_cndmask_b32 v99, v72, v99, s[86:87]
    s_cmp_gt_i32 s82, 6
    s_cselect_b64 s[22:23], 0, -1
    v_cndmask_b32 v100, v72, v100, s[22:23]
    v_cndmask_b32 v101, v72, v101, s[22:23]
    v_cndmask_b32 v102, v72, v102, s[22:23]
    v_cndmask_b32 v103, v72, v103, s[22:23]
    s_cmp_gt_i32 s82, 7
    s_cselect_b64 s[86:87], 0, -1
    v_cndmask_b32 v104, v72, v104, s[86:87]
    v_cndmask_b32 v105, v72, v105, s[86:87]
    v_cndmask_b32 v106, v72, v106, s[86:87]
    v_cndmask_b32 v107, v72, v107, s[86:87]
    s_cmp_gt_i32 s82, 8
    s_cselect_b64 s[22:23], 0, -1
    v_cndmask_b32 v108, v72, v108, s[22:23]
    v_cndmask_b32 v109, v72, v109, s[22:23]
    v_cndmask_b32 v110, v72, v110, s[22:23]
    v_cndmask_b32 v111, v72, v111, s[22:23]
    s_cmp_gt_i32 s82, 9
    s_cselect_b64 s[86:87], 0, -1
    v_cndmask_b32 v112, v72, v112, s[86:87]
    v_cndmask_b32 v113, v72, v113, s[86:87]
    v_cndmask_b32 v114, v72, v114, s[86:87]
    v_cndmask_b32 v115, v72, v115, s[86:87]
    s_cmp_gt_i32 s82, 10
    s_cselect_b64 s[22:23], 0, -1
    v_cndmask_b32 v116, v72, v116, s[22:23]
    v_cndmask_b32 v117, v72, v117, s[22:23]
    v_cndmask_b32 v118, v72, v118, s[22:23]
    v_cndmask_b32 v119, v72, v119, s[22:23]
    s_cmp_gt_i32 s82, 11
    s_cselect_b64 s[86:87], 0, -1
    v_cndmask_b32 v120, v72, v120, s[86:87]
    v_cndmask_b32 v121, v72, v121, s[86:87]
    v_cndmask_b32 v122, v72, v122, s[86:87]
    v_cndmask_b32 v123, v72, v123, s[86:87]
    s_cmp_gt_i32 s82, 12
    s_cselect_b64 s[22:23], 0, -1
    v_cndmask_b32 v124, v72, v124, s[22:23]
    v_cndmask_b32 v125, v72, v125, s[22:23]
    v_cndmask_b32 v126, v72, v126, s[22:23]
    v_cndmask_b32 v127, v72, v127, s[22:23]
    s_cmp_gt_i32 s82, 13
    s_cselect_b64 s[86:87], 0, -1
    v_cndmask_b32 v128, v72, v128, s[86:87]
    v_cndmask_b32 v129, v72, v129, s[86:87]
    v_cndmask_b32 v130, v72, v130, s[86:87]
    v_cndmask_b32 v131, v72, v131, s[86:87]
    s_cmp_gt_i32 s82, 14
    s_cselect_b64 s[22:23], 0, -1
    v_cndmask_b32 v132, v72, v132, s[22:23]
    v_cndmask_b32 v133, v72, v133, s[22:23]
    v_cndmask_b32 v134, v72, v134, s[22:23]
    v_cndmask_b32 v135, v72, v135, s[22:23]
    s_cmp_gt_i32 s82, 15
    s_cselect_b64 s[86:87], 0, -1
    v_cndmask_b32 v136, v72, v136, s[86:87]
    v_cndmask_b32 v137, v72, v137, s[86:87]
    v_cndmask_b32 v138, v72, v138, s[86:87]
    v_cndmask_b32 v139, v72, v139, s[86:87]
    v_max_f32 v73, v76, v77
    v_max_f32 v74, v78, v79
    v_max3_f32 v73, v73, v80, v81
    v_max3_f32 v74, v74, v82, v83
    v_max3_f32 v73, v73, v84, v85
    v_max3_f32 v74, v74, v86, v87
    v_max3_f32 v73, v73, v88, v89
    v_max3_f32 v74, v74, v90, v91
    v_max3_f32 v73, v73, v92, v93
    v_max3_f32 v74, v74, v94, v95
    v_max3_f32 v73, v73, v96, v97
    v_max3_f32 v74, v74, v98, v99
    v_max3_f32 v73, v73, v100, v101
    v_max3_f32 v74, v74, v102, v103
    v_max3_f32 v73, v73, v104, v105
    v_max3_f32 v74, v74, v106, v107
    v_max3_f32 v73, v73, v108, v109
    v_max3_f32 v74, v74, v110, v111
    v_max3_f32 v73, v73, v112, v113
    v_max3_f32 v74, v74, v114, v115
    v_max3_f32 v73, v73, v116, v117
    v_max3_f32 v74, v74, v118, v119
    v_max3_f32 v73, v73, v120, v121
    v_max3_f32 v74, v74, v122, v123
    v_max3_f32 v73, v73, v124, v125
    v_max3_f32 v74, v74, v126, v127
    v_max3_f32 v73, v73, v128, v129
    v_max3_f32 v74, v74, v130, v131
    v_max3_f32 v73, v73, v132, v133
    v_max3_f32 v74, v74, v134, v135
    v_max3_f32 v73, v73, v136, v137
    v_max3_f32 v74, v74, v138, v139
    v_max3_f32 v73, v73, v140, v141
    v_max3_f32 v74, v74, v142, v143
    v_max3_f32 v73, v73, v144, v145
    v_max3_f32 v74, v74, v146, v147
rare_44:
    v_max_f32 v73, v73, v74
    v_mov_b32 v74, v73
    s_nop 1
    v_permlane32_swap_b32 v73, v74
    v_max_f32 v73, v73, v74
    v_mov_b32 v74, v73
    s_nop 1
    v_permlane16_swap_b32 v73, v74
    v_max_f32 v73, v73, v74
    s_waitcnt vmcnt(4)
    buffer_load_dwordx2 v[66:67], v61, s[36:39], 0 offen sc1
    v_mov_b32 v60, s64
    s_add_u32 s82, s68, 524288
    s_cmp_ge_u32 s4, 14
    s_cselect_b32 s82, 0x7ffffff0, s82
    s_mov_b64 exec, 1
    buffer_store_dword v60, off, s[36:39], s82 sc1
    s_mov_b64 exec, -1
    buffer_load_dwordx2 v[64:65], v150, s[36:39], 0 offen sc1
    v_sub_f32 v76, v76, v73
    v_sub_f32 v77, v77, v73
    v_sub_f32 v78, v78, v73
    v_sub_f32 v79, v79, v73
    v_sub_f32 v80, v80, v73
    v_sub_f32 v81, v81, v73
    v_sub_f32 v82, v82, v73
    v_sub_f32 v83, v83, v73
    v_exp_f32 v76, v76
    v_exp_f32 v77, v77
    v_exp_f32 v78, v78
    v_exp_f32 v79, v79
    v_exp_f32 v80, v80
    v_exp_f32 v81, v81
    v_exp_f32 v82, v82
    v_exp_f32 v83, v83
    v_cvt_pk_bf16_f32 v76, v76, v77
    v_cvt_pk_bf16_f32 v77, v78, v79
    v_cvt_pk_bf16_f32 v78, v80, v81
    v_cvt_pk_bf16_f32 v79, v82, v83
    s_add_u32 m0, s66, 139264
    s_add_u32 s82, s61, 0
    buffer_load_dwordx4 v3, s[24:27], s82 offen lds
    v_sub_f32 v84, v84, v73
    v_sub_f32 v85, v85, v73
    v_sub_f32 v86, v86, v73
    v_sub_f32 v87, v87, v73
    v_sub_f32 v88, v88, v73
    v_sub_f32 v89, v89, v73
    v_sub_f32 v90, v90, v73
    v_sub_f32 v91, v91, v73
    v_exp_f32 v84, v84
    v_exp_f32 v85, v85
    v_exp_f32 v86, v86
    v_exp_f32 v87, v87
    v_exp_f32 v88, v88
    v_exp_f32 v89, v89
    v_exp_f32 v90, v90
    v_exp_f32 v91, v91
    v_cvt_pk_bf16_f32 v84, v84, v85
    v_cvt_pk_bf16_f32 v85, v86, v87
    v_cvt_pk_bf16_f32 v86, v88, v89
    v_cvt_pk_bf16_f32 v87, v90, v91
    s_waitcnt vmcnt(3)
    v_mov_b32 v62, v66
    s_add_u32 m0, s101, 24576
    s_add_u32 s82, s0, s41
    buffer_load_dwordx4 v75, s[36:39], s82 offen sc1 lds
    s_add_u32 m0, s101, 25600
    s_add_u32 s82, s1, s41
    buffer_load_dwordx4 v75, s[36:39], s82 offen sc1 lds
    s_add_u32 m0, s101, 26624
    s_add_u32 s82, s69, s41
    buffer_load_dwordx4 v75, s[36:39], s82 offen sc1 lds
    s_add_u32 m0, s66, 147456
    s_add_u32 s82, s61, 114688
    buffer_load_dwordx4 v3, s[24:27], s82 offen lds
    v_sub_f32 v92, v92, v73
    v_sub_f32 v93, v93, v73
    v_sub_f32 v94, v94, v73
    v_sub_f32 v95, v95, v73
    v_sub_f32 v96, v96, v73
    v_sub_f32 v97, v97, v73
    v_sub_f32 v98, v98, v73
    v_sub_f32 v99, v99, v73
    v_exp_f32 v92, v92
    v_exp_f32 v93, v93
    v_exp_f32 v94, v94
    v_exp_f32 v95, v95
    v_exp_f32 v96, v96
    v_exp_f32 v97, v97
    v_exp_f32 v98, v98
    v_exp_f32 v99, v99
    v_cvt_pk_bf16_f32 v92, v92, v93
    v_cvt_pk_bf16_f32 v93, v94, v95
    v_cvt_pk_bf16_f32 v94, v96, v97
    v_cvt_pk_bf16_f32 v95, v98, v99
    s_waitcnt vmcnt(5)
    v_mov_b32 v63, v64
    s_add_u32 s82, s56, s63
    buffer_load_dwordx4 v[152:155], v75, s[36:39], s82 offen offset:0 sc1
    buffer_load_dwordx4 v[156:159], v75, s[36:39], s82 offen offset:1024 sc1
    s_add_u32 s82, s57, s63
    buffer_load_dwordx4 v[160:163], v75, s[36:39], s82 offen offset:0 sc1
    buffer_load_dwordx4 v[164:167], v75, s[36:39], s82 offen offset:1024 sc1
    v_sub_f32 v100, v100, v73
    v_sub_f32 v101, v101, v73
    v_sub_f32 v102, v102, v73
    v_sub_f32 v103, v103, v73
    v_sub_f32 v104, v104, v73
    v_sub_f32 v105, v105, v73
    v_sub_f32 v106, v106, v73
    v_sub_f32 v107, v107, v73
    v_exp_f32 v100, v100
    v_exp_f32 v101, v101
    v_exp_f32 v102, v102
    v_exp_f32 v103, v103
    v_exp_f32 v104, v104
    v_exp_f32 v105, v105
    v_exp_f32 v106, v106
    v_exp_f32 v107, v107
    v_cvt_pk_bf16_f32 v100, v100, v101
    v_cvt_pk_bf16_f32 v101, v102, v103
    v_cvt_pk_bf16_f32 v102, v104, v105
    v_cvt_pk_bf16_f32 v103, v106, v107
    s_add_u32 s82, s58, s63
    buffer_load_dwordx4 v[168:171], v75, s[36:39], s82 offen offset:0 sc1
    buffer_load_dwordx4 v[172:175], v75, s[36:39], s82 offen offset:1024 sc1
    s_add_u32 s82, s59, s63
    buffer_load_dwordx4 v[176:179], v75, s[36:39], s82 offen offset:0 sc1
    buffer_load_dwordx4 v[180:183], v75, s[36:39], s82 offen offset:1024 sc1
    v_sub_f32 v108, v108, v73
    v_sub_f32 v109, v109, v73
    v_sub_f32 v110, v110, v73
    v_sub_f32 v111, v111, v73
    v_sub_f32 v112, v112, v73
    v_sub_f32 v113, v113, v73
    v_sub_f32 v114, v114, v73
    v_sub_f32 v115, v115, v73
    v_exp_f32 v108, v108
    v_exp_f32 v109, v109
    v_exp_f32 v110, v110
    v_exp_f32 v111, v111
    v_exp_f32 v112, v112
    v_exp_f32 v113, v113
    v_exp_f32 v114, v114
    v_exp_f32 v115, v115
    v_cvt_pk_bf16_f32 v108, v108, v109
    v_cvt_pk_bf16_f32 v109, v110, v111
    v_cvt_pk_bf16_f32 v110, v112, v113
    v_cvt_pk_bf16_f32 v111, v114, v115
    v_xor_b32 v62, s64, v66
    v_mov_b32 v63, s64
    v_bitop3_b32 v62, v67, v63, v62 bitop3:0xbe
    v_cmp_ne_u32 vcc, 0, v62
    s_cbranch_vccnz chk_45_slow
chk_45_back:
    s_waitcnt vmcnt(9)
    s_barrier
    ds_read_b128 v[4:7], v149 offset:0
    ds_read_b128 v[8:11], v57 offset:1024
    ds_read_b128 v[12:15], v149 offset:2048
    ds_read_b128 v[16:19], v57 offset:3072
    ds_read_b128 v[20:23], v149 offset:4096
    ds_read_b128 v[24:27], v57 offset:5120
    ds_read_b128 v[28:31], v149 offset:6144
    ds_read_b128 v[32:35], v57 offset:7168
    s_add_u32 s82, s60, s63
    buffer_load_dwordx4 v[184:187], v75, s[36:39], s82 offen offset:0 sc1
    buffer_load_dwordx4 v[188:191], v75, s[36:39], s82 offen offset:1024 sc1
    s_add_u32 s82, s61, s63
    buffer_load_dwordx4 v[192:195], v75, s[36:39], s82 offen offset:0 sc1
    buffer_load_dwordx4 v[196:199], v75, s[36:39], s82 offen offset:1024 sc1
    v_sub_f32 v116, v116, v73
    v_sub_f32 v117, v117, v73
    v_sub_f32 v118, v118, v73
    v_sub_f32 v119, v119, v73
    v_sub_f32 v120, v120, v73
    v_sub_f32 v121, v121, v73
    v_sub_f32 v122, v122, v73
    v_sub_f32 v123, v123, v73
    v_exp_f32 v116, v116
    v_exp_f32 v117, v117
    s_waitcnt lgkmcnt(7)
    v_mfma_f32_16x16x32_bf16 v[36:39], v[4:7], v[76:79], 0
    s_waitcnt lgkmcnt(6)
    v_mfma_f32_16x16x32_bf16 v[40:43], v[8:11], v[76:79], 0
    ds_read_b128 v[4:7], v149 offset:8192
    ds_read_b128 v[8:11], v57 offset:9216
    v_exp_f32 v118, v118
    v_exp_f32 v119, v119
    v_exp_f32 v120, v120
    s_waitcnt lgkmcnt(7)
    v_mfma_f32_16x16x32_bf16 v[36:39], v[12:15], v[84:87], v[36:39]
    s_waitcnt lgkmcnt(6)
    v_mfma_f32_16x16x32_bf16 v[40:43], v[16:19], v[84:87], v[40:43]
    ds_read_b128 v[12:15], v149 offset:10240
    ds_read_b128 v[16:19], v57 offset:11264
    v_exp_f32 v121, v121
    v_exp_f32 v122, v122
    v_exp_f32 v123, v123
    s_waitcnt lgkmcnt(7)
    v_mfma_f32_16x16x32_bf16 v[36:39], v[20:23], v[92:95], v[36:39]
    s_waitcnt lgkmcnt(6)
    v_mfma_f32_16x16x32_bf16 v[40:43], v[24:27], v[92:95], v[40:43]
    ds_read_b128 v[20:23], v149 offset:12288
    ds_read_b128 v[24:27], v57 offset:13312
    v_cvt_pk_bf16_f32 v116, v116, v117
    v_cvt_pk_bf16_f32 v117, v118, v119
    v_cvt_pk_bf16_f32 v118, v120, v121
    v_cvt_pk_bf16_f32 v119, v122, v123
    s_waitcnt lgkmcnt(7)
    v_mfma_f32_16x16x32_bf16 v[36:39], v[28:31], v[100:103], v[36:39]
    s_waitcnt lgkmcnt(6)
    v_mfma_f32_16x16x32_bf16 v[40:43], v[32:35], v[100:103], v[40:43]
    ds_read_b128 v[28:31], v149 offset:14336
    ds_read_b128 v[32:35], v57 offset:15360
    s_add_u32 m0, s66, 0
    s_add_u32 s82, s62, 0
    buffer_load_dwordx4 v3, s[24:27], s82 offen lds
    v_sub_f32 v124, v124, v73
    v_sub_f32 v125, v125, v73
    v_sub_f32 v126, v126, v73
    v_sub_f32 v127, v127, v73
    v_sub_f32 v128, v128, v73
    v_sub_f32 v129, v129, v73
    v_sub_f32 v130, v130, v73
    v_sub_f32 v131, v131, v73
    v_exp_f32 v124, v124
    v_exp_f32 v125, v125
    s_waitcnt lgkmcnt(7)
    v_mfma_f32_16x16x32_bf16 v[36:39], v[4:7], v[108:111], v[36:39]
    s_waitcnt lgkmcnt(6)
    v_mfma_f32_16x16x32_bf16 v[40:43], v[8:11], v[108:111], v[40:43]
    ds_read_b128 v[4:7], v149 offset:16384
    ds_read_b128 v[8:11], v57 offset:17408
    v_exp_f32 v126, v126
    v_exp_f32 v127, v127
    v_exp_f32 v128, v128
    s_waitcnt lgkmcnt(7)
    v_mfma_f32_16x16x32_bf16 v[36:39], v[12:15], v[116:119], v[36:39]
    s_waitcnt lgkmcnt(6)
    v_mfma_f32_16x16x32_bf16 v[40:43], v[16:19], v[116:119], v[40:43]
    v_exp_f32 v129, v129
    v_exp_f32 v130, v130
    v_exp_f32 v131, v131
    v_cvt_pk_bf16_f32 v124, v124, v125
    v_cvt_pk_bf16_f32 v125, v126, v127
    v_cvt_pk_bf16_f32 v126, v128, v129
    v_cvt_pk_bf16_f32 v127, v130, v131
    s_waitcnt lgkmcnt(5)
    s_nop 0
    v_mfma_f32_16x16x32_bf16 v[36:39], v[20:23], v[124:127], v[36:39]
    s_waitcnt lgkmcnt(4)
    v_mfma_f32_16x16x32_bf16 v[40:43], v[24:27], v[124:127], v[40:43]
    s_add_u32 s82, s62, s63
    buffer_load_dwordx4 v[200:203], v75, s[36:39], s82 offen offset:0 sc1
    buffer_load_dwordx4 v[204:207], v75, s[36:39], s82 offen offset:1024 sc1
    s_add_u32 m0, s66, 8192
    s_add_u32 s82, s62, 114688
    buffer_load_dwordx4 v3, s[24:27], s82 offen lds
    v_sub_f32 v132, v132, v73
    v_sub_f32 v133, v133, v73
    v_sub_f32 v134, v134, v73
    v_sub_f32 v135, v135, v73
    v_sub_f32 v136, v136, v73
    v_sub_f32 v137, v137, v73
    v_sub_f32 v138, v138, v73
    v_sub_f32 v139, v139, v73
    v_exp_f32 v132, v132
    v_exp_f32 v133, v133
    v_exp_f32 v134, v134
    v_exp_f32 v135, v135
    v_exp_f32 v136, v136
    v_exp_f32 v137, v137
    v_exp_f32 v138, v138
    v_exp_f32 v139, v139
    v_cvt_pk_bf16_f32 v132, v132, v133
    v_cvt_pk_bf16_f32 v133, v134, v135
    v_cvt_pk_bf16_f32 v134, v136, v137
    v_cvt_pk_bf16_f32 v135, v138, v139
    s_waitcnt lgkmcnt(3)
    s_nop 0
    v_mfma_f32_16x16x32_bf16 v[36:39], v[28:31], v[132:135], v[36:39]
    s_waitcnt lgkmcnt(2)
    v_mfma_f32_16x16x32_bf16 v[40:43], v[32:35], v[132:135], v[40:43]
    s_add_u32 m0, s66, 16384
    s_add_u32 s82, s56, 57344
    buffer_load_dwordx4 v3, s[24:27], s82 offen lds
    buffer_load_dwordx2 v[58:59], v151, s[36:39], 0 offen sc1
    v_sub_f32 v140, v140, v73
    v_sub_f32 v141, v141, v73
    v_sub_f32 v142, v142, v73
    v_sub_f32 v143, v143, v73
    v_sub_f32 v144, v144, v73
    v_sub_f32 v145, v145, v73
    v_sub_f32 v146, v146, v73
    v_sub_f32 v147, v147, v73
    v_exp_f32 v140, v140
    v_exp_f32 v141, v141
    v_exp_f32 v142, v142
    v_exp_f32 v143, v143
    v_exp_f32 v144, v144
    v_exp_f32 v145, v145
    v_exp_f32 v146, v146
    v_exp_f32 v147, v147
    v_cvt_pk_bf16_f32 v140, v140, v141
    v_cvt_pk_bf16_f32 v141, v142, v143
    v_cvt_pk_bf16_f32 v142, v144, v145
    v_cvt_pk_bf16_f32 v143, v146, v147
    s_waitcnt lgkmcnt(1)
    s_nop 0
    v_mfma_f32_16x16x32_bf16 v[36:39], v[4:7], v[140:143], v[36:39]
    s_waitcnt lgkmcnt(0)
    v_mfma_f32_16x16x32_bf16 v[40:43], v[8:11], v[140:143], v[40:43]
    s_add_u32 m0, s66, 114688
    s_add_u32 s82, s58, 172032
    buffer_load_dwordx4 v3, s[24:27], s82 offen lds
    s_nop 4
    v_rcp_f32 v74, v43
    s_nop 0
    v_mul_f32 v36, v36, v74
    v_mul_f32 v37, v37, v74
    v_mul_f32 v38, v38, v74
    v_mul_f32 v39, v39, v74
    v_mul_f32 v40, v40, v74
    v_mul_f32 v41, v41, v74
    v_mul_f32 v42, v42, v74
    v_cvt_pk_bf16_f32 v76, v36, v37
    v_cvt_pk_bf16_f32 v77, v38, v39
    v_cvt_pk_bf16_f32 v79, v42, 0
    v_cvt_pk_bf16_f32 v78, v40, v41
    v_or_b32 v79, s76, v79
    buffer_store_dwordx4 v[76:79], v56, s[36:39], s75 offen sc1
    s_waitcnt vmcnt(20)
    s_barrier
    s_cmp_eq_u32 s80, 0
    s_cbranch_scc1 L_idle
    v_xor_b32 v60, s64, v64
    v_mov_b32 v61, s64
    v_bitop3_b32 v60, v65, v61, v60 bitop3:0xbe
    v_cmp_ne_u32 vcc, 0, v60
    s_cbranch_vccnz chk_46_slow0
chk_46_back:
    s_add_u32 s63, s63, 6422528
    ds_read_b64_tr_b16 v[4:5], v44 offset:0
    ds_read_b64_tr_b16 v[6:7], v44 offset:1024
    ds_read_b64_tr_b16 v[8:9], v45 offset:0
    ds_read_b64_tr_b16 v[10:11], v45 offset:1024
    ds_read_b64_tr_b16 v[12:13], v44 offset:8192
    ds_read_b64_tr_b16 v[14:15], v44 offset:9216
    ds_read_b64_tr_b16 v[16:17], v45 offset:8192
    ds_read_b64_tr_b16 v[18:19], v45 offset:9216
    s_add_u32 m0, s66, 24576
    s_add_u32 s82, s56, 172032
    buffer_load_dwordx4 v3, s[24:27], s82 offen lds
    s_waitcnt vmcnt(3)
    v_mov_b32 v67, v58
    s_waitcnt lgkmcnt(6)
    v_mfma_f32_32x32x16_bf16 v[76:91], v[4:7], v[152:155], 0
    s_add_u32 s82, s56, s63
    buffer_load_dwordx4 v[208:211], v75, s[36:39], s82 offen offset:0 sc1
    ds_read_b64_tr_b16 v[20:21], v44 offset:16384
    ds_read_b64_tr_b16 v[22:23], v44 offset:17408
    ds_read_b64_tr_b16 v[24:25], v45 offset:16384
    ds_read_b64_tr_b16 v[26:27], v45 offset:17408
    ds_read_b64_tr_b16 v[28:29], v44 offset:24576
    ds_read_b64_tr_b16 v[30:31], v44 offset:25600
    ds_read_b64_tr_b16 v[32:33], v45 offset:24576
    ds_read_b64_tr_b16 v[34:35], v45 offset:25600
    s_waitcnt lgkmcnt(12)
    v_mfma_f32_32x32x16_bf16 v[92:107], v[8:11], v[152:155], 0
    s_add_u32 s82, s56, s63
    buffer_load_dwordx4 v[212:215], v75, s[36:39], s82 offen offset:1024 sc1
    s_waitcnt lgkmcnt(10)
    v_mfma_f32_32x32x16_bf16 v[76:91], v[12:15], v[156:159], v[76:91]
    s_add_u32 m0, s66, 32768
    s_add_u32 s82, s57, 57344
    buffer_load_dwordx4 v3, s[24:27], s82 offen lds
    s_waitcnt lgkmcnt(8)
    v_mfma_f32_32x32x16_bf16 v[92:107], v[16:19], v[156:159], v[92:107]
    s_add_u32 m0, s66, 40960
    s_add_u32 s82, s57, 172032
    buffer_load_dwordx4 v3, s[24:27], s82 offen lds
    s_mul_i32 s84, s7, 24576
    s_xor_b32 s82, s6, 0
    s_lshl_b32 s82, s82, 11
    s_add_u32 s82, s82, s84
    s_add_u32 s82, s82, 0xb800
    v_add_u32 v144, s82, v75
    v_add_u32 v140, 57344, v144
    s_xor_b32 s82, s6, 1
    s_lshl_b32 s82, s82, 11
    s_add_u32 s82, s82, s84
    s_add_u32 s82, s82, 0xd000
    v_add_u32 v145, s82, v75
    v_add_u32 v141, 57344, v145
    s_xor_b32 s82, s6, 2
    s_lshl_b32 s82, s82, 11
    s_add_u32 s82, s82, s84
    s_add_u32 s82, s82, 0xe800
    v_add_u32 v146, s82, v75
    v_add_u32 v142, 57344, v146
    s_xor_b32 s82, s6, 3
    s_lshl_b32 s82, s82, 11
    s_add_u32 s82, s82, s84
    s_add_u32 s82, s82, 0x10000
    v_add_u32 v147, s82, v75
    v_add_u32 v143, 57344, v147
    s_mul_i32 s82, s6, 6144
    s_add_u32 s82, s82, s84
    s_add_u32 s82, s82, 49152
    v_add_u32 v53, s82, v75
    v_add_u32 v52, 57344, v53
    s_waitcnt lgkmcnt(6)
    v_mfma_f32_32x32x16_bf16 v[76:91], v[20:23], v[160:163], v[76:91]
    s_add_u32 s82, s57, s63
    buffer_load_dwordx4 v[216:219], v75, s[36:39], s82 offen offset:0 sc1
    ds_read_b64_tr_b16 v[4:5], v44 offset:32768
    ds_read_b64_tr_b16 v[6:7], v44 offset:33792
    ds_read_b64_tr_b16 v[8:9], v45 offset:32768
    ds_read_b64_tr_b16 v[10:11], v45 offset:33792
    ds_read_b64_tr_b16 v[12:13], v44 offset:40960
    ds_read_b64_tr_b16 v[14:15], v44 offset:41984
    ds_read_b64_tr_b16 v[16:17], v45 offset:40960
    ds_read_b64_tr_b16 v[18:19], v45 offset:41984
    s_waitcnt lgkmcnt(12)
    v_mfma_f32_32x32x16_bf16 v[92:107], v[24:27], v[160:163], v[92:107]
    s_add_u32 s82, s57, s63
    buffer_load_dwordx4 v[220:223], v75, s[36:39], s82 offen offset:1024 sc1
    s_waitcnt lgkmcnt(10)
    v_mfma_f32_32x32x16_bf16 v[76:91], v[28:31], v[164:167], v[76:91]
    s_add_u32 s82, s58, s63
    buffer_load_dwordx4 v[224:227], v75, s[36:39], s82 offen offset:0 sc1
    s_waitcnt lgkmcnt(8)
    v_mfma_f32_32x32x16_bf16 v[92:107], v[32:35], v[164:167], v[92:107]
    s_add_u32 s82, s58, s63
    buffer_load_dwordx4 v[228:231], v75, s[36:39], s82 offen offset:1024 sc1
    v_bfe_u32 v60, v1, 2, 1
    v_lshrrev_b32 v61, 5, v1
    s_lshr_b32 s82, s6, 1
    s_mul_i32 s82, s82, 3584
    s_and_b32 s83, s6, 1
    s_lshl_b32 s84, s83, 10
    s_add_u32 s82, s82, s84
    s_add_u32 s82, s82, 49152
    v_add_u32 v46, s82, v46
    v_mul_u32_u24 v62, s83, v61
    v_xor_b32 v47, 64, v46
    v_bfe_u32 v60, v1, 2, 2
    v_mad_u32_u24 v60, v61, 3, v60
    s_mul_i32 s83, s83, 6
    v_add_u32 v60, s83, v60
    v_bfe_u32 v62, v60, 1, 1
    v_lshl_add_u32 v60, v60, 7, v50
    v_lshl_add_u32 v60, v62, 6, v60
    s_sub_u32 s82, s82, s84
    s_add_u32 s82, s82, 2048
    v_add_u32 v48, s82, v60
    v_xor_b32 v49, 64, v48
    v_and_b32 v60, 31, v1
    s_lshl_b32 s82, s77, 6
    s_lshl_b32 s83, s7, 5
    s_add_u32 s82, s82, s83
    v_add_u32 v60, s82, v60
    s_movk_i32 s83, 896
    v_mul_u32_u24 v60, s83, v60
    s_lshl_b32 s82, s78, 7
    s_lshl_b32 s83, s6, 5
    s_add_u32 s82, s82, s83
    v_add_u32 v60, s82, v60
    v_lshl_add_u32 v55, v61, 4, v60
    s_waitcnt lgkmcnt(6)
    v_mfma_f32_32x32x16_bf16 v[76:91], v[4:7], v[168:171], v[76:91]
    s_add_u32 s82, s59, s63
    buffer_load_dwordx4 v[232:235], v75, s[36:39], s82 offen offset:0 sc1
    ds_read_b64_tr_b16 v[20:21], v44 offset:49152
    ds_read_b64_tr_b16 v[22:23], v44 offset:50176
    ds_read_b64_tr_b16 v[24:25], v45 offset:49152
    ds_read_b64_tr_b16 v[26:27], v45 offset:50176
    ds_read_b64_tr_b16 v[28:29], v44 offset:57344
    ds_read_b64_tr_b16 v[30:31], v44 offset:58368
    ds_read_b64_tr_b16 v[32:33], v45 offset:57344
    ds_read_b64_tr_b16 v[34:35], v45 offset:58368
    s_waitcnt lgkmcnt(12)
    v_mfma_f32_32x32x16_bf16 v[92:107], v[8:11], v[168:171], v[92:107]
    s_add_u32 s82, s59, s63
    buffer_load_dwordx4 v[236:239], v75, s[36:39], s82 offen offset:1024 sc1
    s_waitcnt lgkmcnt(10)
    v_mfma_f32_32x32x16_bf16 v[76:91], v[12:15], v[172:175], v[76:91]
    s_add_u32 s82, s60, s63
    buffer_load_dwordx4 v[240:243], v75, s[36:39], s82 offen offset:0 sc1
    s_waitcnt lgkmcnt(8)
    v_mfma_f32_32x32x16_bf16 v[92:107], v[16:19], v[172:175], v[92:107]
    s_add_u32 s82, s60, s63
    buffer_load_dwordx4 v[244:247], v75, s[36:39], s82 offen offset:1024 sc1
    s_waitcnt lgkmcnt(6)
    v_mfma_f32_32x32x16_bf16 v[76:91], v[20:23], v[176:179], v[76:91]
    s_add_u32 s82, s61, s63
    buffer_load_dwordx4 v[248:251], v75, s[36:39], s82 offen offset:0 sc1
    s_waitcnt lgkmcnt(4)
    v_mfma_f32_32x32x16_bf16 v[92:107], v[24:27], v[176:179], v[92:107]
    s_add_u32 s82, s61, s63
    buffer_load_dwordx4 v[252:255], v75, s[36:39], s82 offen offset:1024 sc1
    s_waitcnt lgkmcnt(2)
    v_mfma_f32_32x32x16_bf16 v[76:91], v[28:31], v[180:183], v[76:91]
    s_add_u32 s82, s62, s63
    buffer_load_dwordx4 v[152:155], v75, s[36:39], s82 offen offset:0 sc1
    s_waitcnt lgkmcnt(0)
    v_mfma_f32_32x32x16_bf16 v[92:107], v[32:35], v[180:183], v[92:107]
    s_add_u32 s82, s62, s63
    buffer_load_dwordx4 v[156:159], v75, s[36:39], s82 offen offset:1024 sc1
    s_barrier
    v_add_u32 v44, 0x12000, v44
    v_add_u32 v45, 0x12000, v45
    ds_read_b64_tr_b16 v[4:5], v44 offset:0
    ds_read_b64_tr_b16 v[6:7], v44 offset:1024
    ds_read_b64_tr_b16 v[8:9], v45 offset:0
    ds_read_b64_tr_b16 v[10:11], v45 offset:1024
    ds_read_b64_tr_b16 v[12:13], v44 offset:8192
    ds_read_b64_tr_b16 v[14:15], v44 offset:9216
    ds_read_b64_tr_b16 v[16:17], v45 offset:8192
    ds_read_b64_tr_b16 v[18:19], v45 offset:9216
    s_add_u32 m0, s66, 106496
    s_add_u32 s82, s58, 57344
    buffer_load_dwordx4 v3, s[24:27], s82 offen lds
    s_waitcnt lgkmcnt(6)
    v_mfma_f32_32x32x16_bf16 v[76:91], v[4:7], v[184:187], v[76:91]
    s_add_u32 m0, s66, 49152
    s_mov_b32 s82, 0
    buffer_load_dwordx4 v3, s[28:31], s82 offen lds
    ds_read_b64_tr_b16 v[20:21], v44 offset:16384
    ds_read_b64_tr_b16 v[22:23], v44 offset:17408
    ds_read_b64_tr_b16 v[24:25], v45 offset:16384
    ds_read_b64_tr_b16 v[26:27], v45 offset:17408
    ds_read_b64_tr_b16 v[28:29], v44 offset:24576
    ds_read_b64_tr_b16 v[30:31], v44 offset:25600
    ds_read_b64_tr_b16 v[32:33], v45 offset:24576
    ds_read_b64_tr_b16 v[34:35], v45 offset:25600
    s_waitcnt lgkmcnt(12)
    v_mfma_f32_32x32x16_bf16 v[92:107], v[8:11], v[184:187], v[92:107]
    s_add_u32 m0, s66, 57344
    s_mov_b32 s82, 57344
    buffer_load_dwordx4 v3, s[28:31], s82 offen lds
    s_waitcnt lgkmcnt(10)
    v_mfma_f32_32x32x16_bf16 v[76:91], v[12:15], v[188:191], v[76:91]
    s_add_u32 m0, s66, 65536
    s_mov_b32 s82, 114688
    buffer_load_dwordx4 v3, s[28:31], s82 offen lds
    s_waitcnt lgkmcnt(8)
    v_mfma_f32_32x32x16_bf16 v[92:107], v[16:19], v[188:191], v[92:107]
    s_add_u32 m0, s66, 73728
    s_mov_b32 s82, 172032
    buffer_load_dwordx4 v3, s[28:31], s82 offen lds
    s_waitcnt lgkmcnt(6)
    v_mfma_f32_32x32x16_bf16 v[76:91], v[20:23], v[192:195], v[76:91]
    s_add_u32 m0, s66, 81920
    s_mov_b32 s82, 229376
    buffer_load_dwordx4 v3, s[28:31], s82 offen lds
    s_waitcnt lgkmcnt(4)
    v_mfma_f32_32x32x16_bf16 v[92:107], v[24:27], v[192:195], v[92:107]
    s_add_u32 m0, s66, 90112
    s_mov_b32 s82, 286720
    buffer_load_dwordx4 v3, s[28:31], s82 offen lds
    s_waitcnt lgkmcnt(2)
    v_mfma_f32_32x32x16_bf16 v[76:91], v[28:31], v[196:199], v[76:91]
    s_add_u32 m0, s66, 98304
    s_mov_b32 s82, 344064
    buffer_load_dwordx4 v3, s[28:31], s82 offen lds
    s_waitcnt lgkmcnt(0)
    v_mfma_f32_32x32x16_bf16 v[92:107], v[32:35], v[196:199], v[92:107]
    s_waitcnt vmcnt(20)
    s_barrier
    v_add_u32 v44, 0xfffe2000, v44
    v_add_u32 v45, 0xfffe2000, v45
    ds_read_b64_tr_b16 v[4:5], v44 offset:0
    ds_read_b64_tr_b16 v[6:7], v44 offset:1024
    ds_read_b64_tr_b16 v[8:9], v45 offset:0
    ds_read_b64_tr_b16 v[10:11], v45 offset:1024
    ds_read_b64_tr_b16 v[12:13], v44 offset:8192
    ds_read_b64_tr_b16 v[14:15], v44 offset:9216
    ds_read_b64_tr_b16 v[16:17], v45 offset:8192
    ds_read_b64_tr_b16 v[18:19], v45 offset:9216
    s_add_u32 s82, s43, 0
    buffer_load_dwordx4 v[160:163], v75, s[36:39], s82 offen sc1
    s_waitcnt lgkmcnt(6)
    v_mfma_f32_32x32x16_bf16 v[76:91], v[4:7], v[200:203], v[76:91]
    s_add_u32 s82, s43, 4096
    buffer_load_dwordx4 v[164:167], v75, s[36:39], s82 offen sc1
    ds_read_b64_tr_b16 v[20:21], v44 offset:16384
    ds_read_b64_tr_b16 v[22:23], v44 offset:17408
    ds_read_b64_tr_b16 v[24:25], v45 offset:16384
    ds_read_b64_tr_b16 v[26:27], v45 offset:17408
    ds_read_b64_tr_b16 v[28:29], v44 offset:24576
    ds_read_b64_tr_b16 v[30:31], v44 offset:25600
    ds_read_b64_tr_b16 v[32:33], v45 offset:24576
    ds_read_b64_tr_b16 v[34:35], v45 offset:25600
    s_waitcnt lgkmcnt(12)
    v_mfma_f32_32x32x16_bf16 v[92:107], v[8:11], v[200:203], v[92:107]
    s_waitcnt lgkmcnt(10)
    v_mfma_f32_32x32x16_bf16 v[76:91], v[12:15], v[204:207], v[76:91]
    s_add_u32 s82, s43, 8192
    buffer_load_dwordx4 v[168:171], v75, s[36:39], s82 offen sc1
    s_waitcnt lgkmcnt(8)
    v_mfma_f32_32x32x16_bf16 v[92:107], v[16:19], v[204:207], v[92:107]
    v_xor_b32 v60, s64, v58
    v_mov_b32 v61, s64
    v_bitop3_b32 v60, v59, v61, v60 bitop3:0xbe
    v_cmp_ne_u32 vcc, 0, v60
    s_cbranch_vccnz chk_47_slow0
chk_47_back:
    s_waitcnt lgkmcnt(6)
    v_mfma_f32_32x32x16_bf16 v[76:91], v[20:23], v[208:211], v[76:91]
    s_add_u32 s82, s43, 12288
    buffer_load_dwordx4 v[172:175], v75, s[36:39], s82 offen sc1
    s_waitcnt lgkmcnt(4)
    v_mfma_f32_32x32x16_bf16 v[92:107], v[24:27], v[208:211], v[92:107]
    s_add_u32 s82, s43, 16384
    buffer_load_dwordx4 v[176:179], v75, s[36:39], s82 offen sc1
    s_waitcnt lgkmcnt(2)
    v_mfma_f32_32x32x16_bf16 v[76:91], v[28:31], v[212:215], v[76:91]
    s_add_u32 s82, s43, 20480
    buffer_load_dwordx4 v[180:183], v75, s[36:39], s82 offen sc1
    s_waitcnt lgkmcnt(0)
    v_mfma_f32_32x32x16_bf16 v[92:107], v[32:35], v[212:215], v[92:107]
    s_waitcnt vmcnt(6)
    s_barrier
    ds_read_b64_tr_b16 v[4:5], v44 offset:32768
    ds_read_b64_tr_b16 v[6:7], v44 offset:33792
    ds_read_b64_tr_b16 v[8:9], v45 offset:32768
    ds_read_b64_tr_b16 v[10:11], v45 offset:33792
    ds_read_b64_tr_b16 v[12:13], v44 offset:40960
    ds_read_b64_tr_b16 v[14:15], v44 offset:41984
    ds_read_b64_tr_b16 v[16:17], v45 offset:40960
    ds_read_b64_tr_b16 v[18:19], v45 offset:41984
    s_add_u32 s82, s43, 24576
    buffer_load_dwordx4 v[184:187], v75, s[36:39], s82 offen sc1
    s_waitcnt lgkmcnt(6)
    v_mfma_f32_32x32x16_bf16 v[76:91], v[4:7], v[216:219], v[76:91]
    s_add_u32 s82, s43, 28672
    buffer_load_dwordx4 v[188:191], v75, s[36:39], s82 offen sc1
    v_add_u32 v44, 0x1a000, v44
    v_add_u32 v45, 0x1a000, v45
    ds_read_b64_tr_b16 v[20:21], v44 offset:0
    ds_read_b64_tr_b16 v[22:23], v44 offset:1024
    ds_read_b64_tr_b16 v[24:25], v45 offset:0
    ds_read_b64_tr_b16 v[26:27], v45 offset:1024
    ds_read_b64_tr_b16 v[28:29], v44 offset:8192
    ds_read_b64_tr_b16 v[30:31], v44 offset:9216
    ds_read_b64_tr_b16 v[32:33], v45 offset:8192
    ds_read_b64_tr_b16 v[34:35], v45 offset:9216
    s_waitcnt lgkmcnt(12)
    v_mfma_f32_32x32x16_bf16 v[92:107], v[8:11], v[216:219], v[92:107]
    s_add_u32 m0, s66, 122880
    s_add_u32 s82, s59, 57344
    buffer_load_dwordx4 v3, s[24:27], s82 offen lds
    s_waitcnt lgkmcnt(10)
    v_mfma_f32_32x32x16_bf16 v[76:91], v[12:15], v[220:223], v[76:91]
    s_add_u32 m0, s66, 131072
    s_add_u32 s82, s59, 172032
    buffer_load_dwordx4 v3, s[24:27], s82 offen lds
    s_waitcnt lgkmcnt(8)
    v_mfma_f32_32x32x16_bf16 v[92:107], v[16:19], v[220:223], v[92:107]
    s_waitcnt lgkmcnt(6)
    v_mfma_f32_32x32x16_bf16 v[76:91], v[20:23], v[224:227], v[76:91]
    s_add_u32 m0, s66, 139264
    s_add_u32 s82, s60, 57344
    buffer_load_dwordx4 v3, s[24:27], s82 offen lds
    s_waitcnt lgkmcnt(4)
    v_mfma_f32_32x32x16_bf16 v[92:107], v[24:27], v[224:227], v[92:107]
    s_waitcnt lgkmcnt(2)
    v_mfma_f32_32x32x16_bf16 v[76:91], v[28:31], v[228:231], v[76:91]
    s_add_u32 m0, s66, 147456
    s_add_u32 s82, s60, 172032
    buffer_load_dwordx4 v3, s[24:27], s82 offen lds
    s_waitcnt lgkmcnt(0)
    v_mfma_f32_32x32x16_bf16 v[92:107], v[32:35], v[228:231], v[92:107]
    ds_read_b64_tr_b16 v[4:5], v46 offset:0
    ds_read_b64_tr_b16 v[6:7], v48 offset:0
    ds_read_b64_tr_b16 v[8:9], v47 offset:0
    ds_read_b64_tr_b16 v[10:11], v49 offset:0
    ds_read_b64_tr_b16 v[12:13], v46 offset:7168
    ds_read_b64_tr_b16 v[14:15], v48 offset:7168
    ds_read_b64_tr_b16 v[16:17], v47 offset:7168
    ds_read_b64_tr_b16 v[18:19], v49 offset:7168
    s_waitcnt vmcnt(11)
    v_xor_b32 v163, s76, v163
    v_cmp_lt_u32 vcc, 0xffff, v163
    s_cbranch_vccnz chk_48_slow
chk_48_back:
    s_waitcnt lgkmcnt(6)
    v_mfma_f32_32x32x16_bf16 v[108:123], v[4:7], v[160:163], 0
    s_add_u32 m0, s66, 0
    s_add_u32 s82, s61, 57344
    buffer_load_dwordx4 v3, s[24:27], s82 offen lds
    s_waitcnt lgkmcnt(4)
    v_mfma_f32_32x32x16_bf16 v[124:139], v[8:11], v[160:163], 0
    s_add_u32 m0, s66, 8192
    s_add_u32 s82, s61, 172032
    buffer_load_dwordx4 v3, s[24:27], s82 offen lds
    ds_read_b64_tr_b16 v[4:5], v46 offset:14336
    ds_read_b64_tr_b16 v[6:7], v48 offset:14336
    ds_read_b64_tr_b16 v[8:9], v47 offset:14336
    ds_read_b64_tr_b16 v[10:11], v49 offset:14336
    s_waitcnt vmcnt(12)
    v_xor_b32 v167, s76, v167
    v_cmp_lt_u32 vcc, 0xffff, v167
    s_cbranch_vccnz chk_49_slow
chk_49_back:
    s_waitcnt lgkmcnt(6)
    v_mfma_f32_32x32x16_bf16 v[108:123], v[12:15], v[164:167], v[108:123]
    s_waitcnt lgkmcnt(4)
    v_mfma_f32_32x32x16_bf16 v[124:139], v[16:19], v[164:167], v[124:139]
    s_add_u32 m0, s66, 16384
    s_add_u32 s82, s62, 57344
    buffer_load_dwordx4 v3, s[24:27], s82 offen lds
    ds_read_b64_tr_b16 v[12:13], v46 offset:21504
    ds_read_b64_tr_b16 v[14:15], v48 offset:21504
    ds_read_b64_tr_b16 v[16:17], v47 offset:21504
    ds_read_b64_tr_b16 v[18:19], v49 offset:21504
    s_waitcnt vmcnt(12)
    v_xor_b32 v171, s76, v171
    v_cmp_lt_u32 vcc, 0xffff, v171
    s_cbranch_vccnz chk_50_slow
chk_50_back:
    s_waitcnt lgkmcnt(6)
    v_mfma_f32_32x32x16_bf16 v[108:123], v[4:7], v[168:171], v[108:123]
    s_add_u32 m0, s66, 24576
    s_add_u32 s82, s62, 172032
    buffer_load_dwordx4 v3, s[24:27], s82 offen lds
    s_waitcnt lgkmcnt(4)
    v_mfma_f32_32x32x16_bf16 v[124:139], v[8:11], v[168:171], v[124:139]
    ds_read_b64_tr_b16 v[4:5], v46 offset:28672
    ds_read_b64_tr_b16 v[6:7], v48 offset:28672
    ds_read_b64_tr_b16 v[8:9], v47 offset:28672
    ds_read_b64_tr_b16 v[10:11], v49 offset:28672
    s_waitcnt vmcnt(12)
    v_xor_b32 v175, s76, v175
    v_cmp_lt_u32 vcc, 0xffff, v175
    s_cbranch_vccnz chk_51_slow
chk_51_back:
    s_waitcnt lgkmcnt(6)
    v_mfma_f32_32x32x16_bf16 v[108:123], v[12:15], v[172:175], v[108:123]
    buffer_load_dwordx4 v[148:151], v55, s[8:11], 0 offen
    s_waitcnt lgkmcnt(4)
    v_mfma_f32_32x32x16_bf16 v[124:139], v[16:19], v[172:175], v[124:139]
    ds_read_b64_tr_b16 v[12:13], v46 offset:35840
    ds_read_b64_tr_b16 v[14:15], v48 offset:35840
    ds_read_b64_tr_b16 v[16:17], v47 offset:35840
    ds_read_b64_tr_b16 v[18:19], v49 offset:35840
    s_waitcnt vmcnt(12)
    v_xor_b32 v179, s76, v179
    v_cmp_lt_u32 vcc, 0xffff, v179
    s_cbranch_vccnz chk_52_slow
chk_52_back:
    s_waitcnt lgkmcnt(6)
    v_mfma_f32_32x32x16_bf16 v[108:123], v[4:7], v[176:179], v[108:123]
    s_waitcnt lgkmcnt(4)
    v_mfma_f32_32x32x16_bf16 v[124:139], v[8:11], v[176:179], v[124:139]
    ds_read_b64_tr_b16 v[4:5], v46 offset:43008
    ds_read_b64_tr_b16 v[6:7], v48 offset:43008
    ds_read_b64_tr_b16 v[8:9], v47 offset:43008
    ds_read_b64_tr_b16 v[10:11], v49 offset:43008
    s_waitcnt vmcnt(11)
    v_xor_b32 v183, s76, v183
    v_cmp_lt_u32 vcc, 0xffff, v183
    s_cbranch_vccnz chk_53_slow
chk_53_back:
    s_waitcnt lgkmcnt(6)
    v_mfma_f32_32x32x16_bf16 v[108:123], v[12:15], v[180:183], v[108:123]
    s_waitcnt lgkmcnt(4)
    v_mfma_f32_32x32x16_bf16 v[124:139], v[16:19], v[180:183], v[124:139]
    ds_read_b64_tr_b16 v[12:13], v46 offset:50176
    ds_read_b64_tr_b16 v[14:15], v48 offset:50176
    ds_read_b64_tr_b16 v[16:17], v47 offset:50176
    ds_read_b64_tr_b16 v[18:19], v49 offset:50176
    s_waitcnt vmcnt(10)
    v_xor_b32 v187, s76, v187
    v_cmp_lt_u32 vcc, 0xffff, v187
    s_cbranch_vccnz chk_54_slow
chk_54_back:
    s_waitcnt lgkmcnt(6)
    v_mfma_f32_32x32x16_bf16 v[108:123], v[4:7], v[184:187], v[108:123]
    s_waitcnt lgkmcnt(4)
    v_mfma_f32_32x32x16_bf16 v[124:139], v[8:11], v[184:187], v[124:139]
    s_waitcnt vmcnt(9)
    v_xor_b32 v191, s76, v191
    v_cmp_lt_u32 vcc, 0xffff, v191
    s_cbranch_vccnz chk_55_slow
chk_55_back:
    s_waitcnt lgkmcnt(2)
    v_mfma_f32_32x32x16_bf16 v[108:123], v[12:15], v[188:191], v[108:123]
    s_waitcnt lgkmcnt(0)
    v_mfma_f32_32x32x16_bf16 v[124:139], v[16:19], v[188:191], v[124:139]
    s_waitcnt vmcnt(5)
    s_barrier
    ds_read_b64_tr_b16 v[4:5], v44 offset:16384
    ds_read_b64_tr_b16 v[6:7], v44 offset:17408
    ds_read_b64_tr_b16 v[8:9], v45 offset:16384
    ds_read_b64_tr_b16 v[10:11], v45 offset:17408
    ds_read_b64_tr_b16 v[12:13], v44 offset:24576
    ds_read_b64_tr_b16 v[14:15], v44 offset:25600
    ds_read_b64_tr_b16 v[16:17], v45 offset:24576
    ds_read_b64_tr_b16 v[18:19], v45 offset:25600
    s_cmp_eq_u32 s6, 0
    s_cselect_b64 exec, 0, -1
    ds_write_b128 v144, v[108:111] offset:0
    s_mov_b64 exec, -1
    s_cmp_eq_u32 s6, 0
    s_cselect_b64 exec, 0, -1
    ds_write_b128 v144, v[112:115] offset:1024
    s_mov_b64 exec, -1
    s_waitcnt lgkmcnt(6)
    v_mfma_f32_32x32x16_bf16 v[76:91], v[4:7], v[232:235], v[76:91]
    s_cmp_eq_u32 s6, 1
    s_cselect_b64 exec, 0, -1
    ds_write_b128 v145, v[116:119] offset:0
    s_mov_b64 exec, -1
    ds_read_b64_tr_b16 v[20:21], v44 offset:32768
    ds_read_b64_tr_b16 v[22:23], v44 offset:33792
    ds_read_b64_tr_b16 v[24:25], v45 offset:32768
    ds_read_b64_tr_b16 v[26:27], v45 offset:33792
    ds_read_b64_tr_b16 v[28:29], v44 offset:40960
    ds_read_b64_tr_b16 v[30:31], v44 offset:41984
    ds_read_b64_tr_b16 v[32:33], v45 offset:40960
    ds_read_b64_tr_b16 v[34:35], v45 offset:41984
    s_waitcnt lgkmcnt(12)
    v_mfma_f32_32x32x16_bf16 v[92:107], v[8:11], v[232:235], v[92:107]
    s_cmp_eq_u32 s6, 1
    s_cselect_b64 exec, 0, -1
    ds_write_b128 v145, v[120:123] offset:1024
    s_mov_b64 exec, -1
    s_cmp_eq_u32 s6, 2
    s_cselect_b64 exec, 0, -1
    ds_write_b128 v146, v[124:127] offset:0
    s_mov_b64 exec, -1
    s_waitcnt lgkmcnt(10)
    v_mfma_f32_32x32x16_bf16 v[76:91], v[12:15], v[236:239], v[76:91]
    s_cmp_eq_u32 s6, 2
    s_cselect_b64 exec, 0, -1
    ds_write_b128 v146, v[128:131] offset:1024
    s_mov_b64 exec, -1
    s_waitcnt lgkmcnt(8)
    v_mfma_f32_32x32x16_bf16 v[92:107], v[16:19], v[236:239], v[92:107]
    s_cmp_eq_u32 s6, 3
    s_cselect_b64 exec, 0, -1
    ds_write_b128 v147, v[132:135] offset:0
    s_mov_b64 exec, -1
    s_waitcnt lgkmcnt(6)
    v_mfma_f32_32x32x16_bf16 v[76:91], v[20:23], v[240:243], v[76:91]
    s_cmp_eq_u32 s6, 3
    s_cselect_b64 exec, 0, -1
    ds_write_b128 v147, v[136:139] offset:1024
    s_mov_b64 exec, -1
    s_waitcnt lgkmcnt(4)
    v_mfma_f32_32x32x16_bf16 v[92:107], v[24:27], v[240:243], v[92:107]
    s_cmp_lg_u32 s6, 1
    s_cbranch_scc1 own_56
    v_mov_b32 v108, v116
    v_mov_b32 v109, v117
    v_mov_b32 v110, v118
    v_mov_b32 v111, v119
    v_mov_b32 v112, v120
    v_mov_b32 v113, v121
    v_mov_b32 v114, v122
    v_mov_b32 v115, v123
own_56:
    s_waitcnt lgkmcnt(2)
    v_mfma_f32_32x32x16_bf16 v[76:91], v[28:31], v[244:247], v[76:91]
    s_cmp_lg_u32 s6, 2
    s_cbranch_scc1 own_57
    v_mov_b32 v108, v124
    v_mov_b32 v109, v125
    v_mov_b32 v110, v126
    v_mov_b32 v111, v127
    v_mov_b32 v112, v128
    v_mov_b32 v113, v129
    v_mov_b32 v114, v130
    v_mov_b32 v115, v131
own_57:
    s_waitcnt lgkmcnt(0)
    v_mfma_f32_32x32x16_bf16 v[92:107], v[32:35], v[244:247], v[92:107]
    s_cmp_lg_u32 s6, 3
    s_cbranch_scc1 own_58
    v_mov_b32 v108, v132
    v_mov_b32 v109, v133
    v_mov_b32 v110, v134
    v_mov_b32 v111, v135
    v_mov_b32 v112, v136
    v_mov_b32 v113, v137
    v_mov_b32 v114, v138
    v_mov_b32 v115, v139
own_58:
    s_waitcnt vmcnt(1)
    s_barrier
    ds_read_b128 v[160:163], v53 offset:0
    ds_read_b128 v[164:167], v53 offset:1024
    ds_read_b128 v[168:171], v53 offset:2048
    ds_read_b128 v[172:175], v53 offset:3072
    ds_read_b128 v[176:179], v53 offset:4096
    ds_read_b128 v[180:183], v53 offset:5120
    v_add_u32 v44, 0xfffe6000, v44
    v_add_u32 v45, 0xfffe6000, v45
    ds_read_b64_tr_b16 v[4:5], v44 offset:0
    ds_read_b64_tr_b16 v[6:7], v44 offset:1024
    ds_read_b64_tr_b16 v[12:13], v44 offset:8192
    ds_read_b64_tr_b16 v[14:15], v44 offset:9216
    ds_read_b64_tr_b16 v[20:21], v44 offset:16384
    ds_read_b64_tr_b16 v[22:23], v44 offset:17408
    ds_read_b64_tr_b16 v[28:29], v44 offset:24576
    ds_read_b64_tr_b16 v[30:31], v44 offset:25600
    ds_read_b64_tr_b16 v[8:9], v45 offset:0
    s_waitcnt lgkmcnt(14)
    ds_read_b64_tr_b16 v[10:11], v45 offset:1024
    s_waitcnt lgkmcnt(14)
    ds_read_b64_tr_b16 v[16:17], v45 offset:8192
    s_waitcnt lgkmcnt(14)
    ds_read_b64_tr_b16 v[18:19], v45 offset:9216
    s_waitcnt lgkmcnt(14)
    ds_read_b64_tr_b16 v[24:25], v45 offset:16384
    s_waitcnt lgkmcnt(14)
    ds_read_b64_tr_b16 v[26:27], v45 offset:17408
    s_waitcnt lgkmcnt(14)
    ds_read_b64_tr_b16 v[32:33], v45 offset:24576
    s_waitcnt lgkmcnt(14)
    ds_read_b64_tr_b16 v[34:35], v45 offset:25600
    s_waitcnt lgkmcnt(14)
    v_mfma_f32_32x32x16_bf16 v[76:91], v[4:7], v[248:251], v[76:91]
    v_add_f32 v160, v160, v108
    v_add_f32 v161, v161, v109
    v_add_f32 v162, v162, v110
    v_add_f32 v163, v163, v111
    v_add_f32 v164, v164, v112
    v_add_f32 v165, v165, v113
    v_add_f32 v166, v166, v114
    v_add_f32 v167, v167, v115
    v_add_f32 v168, v168, v176
    s_waitcnt lgkmcnt(12)
    v_mfma_f32_32x32x16_bf16 v[76:91], v[12:15], v[252:255], v[76:91]
    v_add_f32 v169, v169, v177
    v_add_f32 v170, v170, v178
    v_add_f32 v171, v171, v179
    v_add_f32 v172, v172, v180
    v_add_f32 v173, v173, v181
    v_add_f32 v174, v174, v182
    v_add_f32 v175, v175, v183
    v_add_f32 v160, v160, v168
    s_waitcnt lgkmcnt(10)
    v_mfma_f32_32x32x16_bf16 v[76:91], v[20:23], v[152:155], v[76:91]
    v_add_f32 v161, v161, v169
    v_add_f32 v162, v162, v170
    v_add_f32 v163, v163, v171
    v_add_f32 v164, v164, v172
    v_add_f32 v165, v165, v173
    v_add_f32 v166, v166, v174
    v_add_f32 v167, v167, v175
    s_waitcnt vmcnt(0)
    v_permlane32_swap_b32 v148, v150
    v_permlane32_swap_b32 v149, v151
    s_waitcnt lgkmcnt(8)
    v_mfma_f32_32x32x16_bf16 v[76:91], v[28:31], v[156:159], v[76:91]
    v_lshlrev_b32 v184, 16, v148
    v_and_b32 v185, 0xffff0000, v148
    v_lshlrev_b32 v186, 16, v149
    v_and_b32 v187, 0xffff0000, v149
    v_lshlrev_b32 v188, 16, v150
    v_and_b32 v189, 0xffff0000, v150
    v_lshlrev_b32 v190, 16, v151
    v_and_b32 v191, 0xffff0000, v151
    s_waitcnt lgkmcnt(6)
    v_mfma_f32_32x32x16_bf16 v[92:107], v[8:11], v[248:251], v[92:107]
    s_waitcnt lgkmcnt(4)
    v_mfma_f32_32x32x16_bf16 v[92:107], v[16:19], v[252:255], v[92:107]
    s_waitcnt lgkmcnt(0)
    s_cmp_eq_u32 s6, 0
    s_cselect_b64 exec, 0, -1
    ds_write_b128 v140, v[76:79] offset:0
    s_mov_b64 exec, -1
    s_cmp_eq_u32 s6, 0
    s_cselect_b64 exec, 0, -1
    ds_write_b128 v140, v[80:83] offset:1024
    s_mov_b64 exec, -1
    v_mfma_f32_32x32x16_bf16 v[92:107], v[24:27], v[152:155], v[92:107]
    s_cmp_eq_u32 s6, 1
    s_cselect_b64 exec, 0, -1
    ds_write_b128 v141, v[84:87] offset:0
    s_mov_b64 exec, -1
    s_cmp_eq_u32 s6, 1
    s_cselect_b64 exec, 0, -1
    ds_write_b128 v141, v[88:91] offset:1024
    s_mov_b64 exec, -1
    v_mfma_f32_32x32x16_bf16 v[92:107], v[32:35], v[156:159], v[92:107]
    s_cmp_eq_u32 s6, 2
    s_cselect_b64 exec, 0, -1
    s_nop 9
    ds_write_b128 v142, v[92:95]
    ds_write_b128 v142, v[96:99] offset:1024
    s_mov_b64 exec, -1
    s_cmp_eq_u32 s6, 3
    s_cselect_b64 exec, 0, -1
    ds_write_b128 v143, v[100:103]
    ds_write_b128 v143, v[104:107] offset:1024
    s_mov_b64 exec, -1
    s_cmp_lg_u32 s6, 1
    s_cbranch_scc1 own_59
    v_mov_b32 v76, v84
    v_mov_b32 v77, v85
    v_mov_b32 v78, v86
    v_mov_b32 v79, v87
    v_mov_b32 v80, v88
    v_mov_b32 v81, v89
    v_mov_b32 v82, v90
    v_mov_b32 v83, v91
own_59:
    s_cmp_lg_u32 s6, 2
    s_cbranch_scc1 own_60
    v_mov_b32 v76, v92
    v_mov_b32 v77, v93
    v_mov_b32 v78, v94
    v_mov_b32 v79, v95
    v_mov_b32 v80, v96
    v_mov_b32 v81, v97
    v_mov_b32 v82, v98
    v_mov_b32 v83, v99
own_60:
    s_cmp_lg_u32 s6, 3
    s_cbranch_scc1 own_61
    v_mov_b32 v76, v100
    v_mov_b32 v77, v101
    v_mov_b32 v78, v102
    v_mov_b32 v79, v103
    v_mov_b32 v80, v104
    v_mov_b32 v81, v105
    v_mov_b32 v82, v106
    v_mov_b32 v83, v107
own_61:
    s_waitcnt lgkmcnt(0)
    s_barrier
    ds_read_b128 v[20:23], v52 offset:0
    ds_read_b128 v[24:27], v52 offset:1024
    ds_read_b128 v[28:31], v52 offset:2048
    ds_read_b128 v[32:35], v52 offset:3072
    ds_read_b128 v[36:39], v52 offset:4096
    ds_read_b128 v[40:43], v52 offset:5120
    s_waitcnt lgkmcnt(5)
    v_add_f32 v20, v20, v76
    v_add_f32 v21, v21, v77
    v_add_f32 v22, v22, v78
    v_add_f32 v23, v23, v79
    s_waitcnt lgkmcnt(4)
    v_add_f32 v24, v24, v80
    v_add_f32 v25, v25, v81
    v_add_f32 v26, v26, v82
    v_add_f32 v27, v27, v83
    s_waitcnt lgkmcnt(1)
    v_add_f32 v28, v28, v36
    v_add_f32 v29, v29, v37
    v_add_f32 v30, v30, v38
    v_add_f32 v31, v31, v39
    s_waitcnt lgkmcnt(0)
    v_add_f32 v32, v32, v40
    v_add_f32 v33, v33, v41
    v_add_f32 v34, v34, v42
    v_add_f32 v35, v35, v43
    v_add_f32 v20, v20, v28
    v_add_f32 v21, v21, v29
    v_add_f32 v22, v22, v30
    v_add_f32 v23, v23, v31
    v_add_f32 v24, v24, v32
    v_add_f32 v25, v25, v33
    v_add_f32 v26, v26, v34
    v_add_f32 v27, v27, v35
    v_mul_f32 v28, 0xbfb8aa3b, v20
    v_mul_f32 v29, 0xbfb8aa3b, v21
    v_mul_f32 v30, 0xbfb8aa3b, v22
    v_mul_f32 v31, 0xbfb8aa3b, v23
    v_mul_f32 v32, 0xbfb8aa3b, v24
    v_mul_f32 v33, 0xbfb8aa3b, v25
    v_mul_f32 v34, 0xbfb8aa3b, v26
    v_mul_f32 v35, 0xbfb8aa3b, v27
    v_exp_f32 v28, v28
    v_exp_f32 v29, v29
    v_exp_f32 v30, v30
    v_exp_f32 v31, v31
    v_exp_f32 v32, v32
    v_exp_f32 v33, v33
    v_exp_f32 v34, v34
    v_exp_f32 v35, v35
    v_mul_f32 v20, v20, v160
    v_mul_f32 v21, v21, v161
    v_mul_f32 v22, v22, v162
    v_mul_f32 v23, v23, v163
    v_mul_f32 v24, v24, v164
    v_mul_f32 v25, v25, v165
    v_mul_f32 v26, v26, v166
    v_mul_f32 v27, v27, v167
    v_add_f32 v28, 1.0, v28
    v_add_f32 v29, 1.0, v29
    v_add_f32 v30, 1.0, v30
    v_add_f32 v31, 1.0, v31
    v_add_f32 v32, 1.0, v32
    v_add_f32 v33, 1.0, v33
    v_add_f32 v34, 1.0, v34
    v_add_f32 v35, 1.0, v35
    v_rcp_f32 v28, v28
    v_rcp_f32 v29, v29
    v_rcp_f32 v30, v30
    v_rcp_f32 v31, v31
    v_rcp_f32 v32, v32
    v_rcp_f32 v33, v33
    v_rcp_f32 v34, v34
    v_rcp_f32 v35, v35
    v_fmac_f32 v184, v20, v28
    v_fmac_f32 v185, v21, v29
    v_fmac_f32 v186, v22, v30
    v_fmac_f32 v187, v23, v31
    v_fmac_f32 v188, v24, v32
    v_fmac_f32 v189, v25, v33
    v_fmac_f32 v190, v26, v34
    v_fmac_f32 v191, v27, v35
    v_cvt_pk_bf16_f32 v160, v184, v185
    v_cvt_pk_bf16_f32 v161, v186, v187
    v_cvt_pk_bf16_f32 v162, v188, v189
    v_cvt_pk_bf16_f32 v163, v190, v191
    s_nop 0
    v_permlane32_swap_b32 v160, v162
    v_permlane32_swap_b32 v161, v163
    buffer_store_dwordx4 v[160:163], v55, s[32:35], 0 offen
    s_endpgm
L_idle:
    s_cmp_eq_u32 s2, 255
    s_cbranch_scc0 L_fin
    s_cmp_eq_u32 s5, 0
    s_cbranch_scc0 L_fin
    s_waitcnt vmcnt(0)
    v_lshrrev_b32 v60, 2, v1
    v_and_b32 v61, 3, v1
    v_lshlrev_b32 v60, 11, v60
    v_lshl_add_u32 v60, v61, 7, v60
    v_add_u32 v60, 262144, v60
    buffer_load_dwordx2 v[4:5], v60, s[36:39], 0 offen offset:0 sc1
    buffer_load_dwordx2 v[6:7], v60, s[36:39], 0 offen offset:32 sc1
    buffer_load_dwordx2 v[8:9], v60, s[36:39], 0 offen offset:64 sc1
    buffer_load_dwordx2 v[10:11], v60, s[36:39], 0 offen offset:96 sc1
    s_waitcnt vmcnt(3)
    v_xor_b32 v62, s64, v4
    v_mov_b32 v63, s64
    v_bitop3_b32 v62, v5, v63, v62 bitop3:0xbe
    s_waitcnt vmcnt(2)
    v_bitop3_b32 v62, v6, v63, v62 bitop3:0xbe
    v_bitop3_b32 v62, v7, v63, v62 bitop3:0xbe
    s_waitcnt vmcnt(1)
    v_bitop3_b32 v62, v8, v63, v62 bitop3:0xbe
    v_bitop3_b32 v62, v9, v63, v62 bitop3:0xbe
    s_waitcnt vmcnt(0)
    v_bitop3_b32 v62, v10, v63, v62 bitop3:0xbe
    v_bitop3_b32 v62, v11, v63, v62 bitop3:0xbe
    v_cmp_ne_u32 vcc, 0, v62
    s_cbranch_vccnz chk_62_slow
chk_62_back:
    s_mov_b32 s83, 0
    v_cmp_eq_u32 vcc, 0, v1
    v_mov_b32 v4, 0x7ffffff0
    v_mov_b32 v5, s83
    v_cndmask_b32 v4, v4, v5, vcc
    v_mov_b32 v5, s64
    buffer_store_dword v5, v4, s[36:39], 0 offen sc1
L_fin:
L_end:
    s_endpgm
L_light:
    v_lshrrev_b32 v130, 5, v1
    v_bfe_u32 v131, v1, 2, 3
    v_and_b32 v132, 3, v1
    v_xor_b32 v133, v131, v130
    v_lshlrev_b32 v133, 6, v133
    v_lshl_add_u32 v133, v132, 4, v133
    s_lshl_b32 s82, s5, 3
    v_add_u32 v134, s82, v130
    s_movk_i32 s82, 2688
    v_mad_u32_u24 v3, v134, s82, v133
    s_sub_u32 s83, s4, 14
    s_mul_i32 s83, s83, 384
    s_add_u32 s83, s83, 1792
    v_add_u32 v3, s83, v3
    v_xor_b32 v133, 128, v133
    v_mad_u32_u24 v4, v134, s82, v133
    s_add_u32 s83, s83, 5376
    v_add_u32 v4, s83, v4
    s_lshl_b32 s81, s5, 12
    s_waitcnt lgkmcnt(0)
    s_add_u32 m0, s66, 98304
    s_lshl_b32 s82, s70, 7
    buffer_load_dwordx4 v2, s[8:11], s82 offen lds
    s_add_u32 m0, s66, 106496
    s_lshl_b32 s82, s70, 7
    s_add_u32 s82, s82, 57344
    buffer_load_dwordx4 v2, s[8:11], s82 offen lds
    s_add_u32 m0, s81, 0
    s_mul_i32 s82, s70, 172032
    buffer_load_dwordx4 v3, s[12:15], s82 offen lds
    s_add_u32 m0, s81, 1024
    s_mul_i32 s82, s70, 172032
    buffer_load_dwordx4 v4, s[12:15], s82 offen lds
    s_add_u32 m0, s81, 2048
    s_mul_i32 s82, s70, 172032
    s_add_u32 s82, s82, 10752
    buffer_load_dwordx4 v3, s[12:15], s82 offen lds
    s_add_u32 m0, s81, 3072
    s_mul_i32 s82, s70, 172032
    s_add_u32 s82, s82, 10752
    buffer_load_dwordx4 v4, s[12:15], s82 offen lds
    s_barrier
    s_load_dword s64, s[36:37], 0
    s_lshl_b32 s83, s3, 7
    s_lshl_b32 s82, s4, 3
    s_add_u32 s82, s82, s83
    s_add_u32 s82, s82, s5
    s_mul_i32 s86, s82, 896
    s_lshl_b32 s68, s82, 4
    s_add_u32 s68, s68, 131072
    v_lshlrev_b32 v130, 4, v1
    v_cmp_gt_u32 vcc, 56, v1
    v_mov_b32 v131, 0x7ffffff0
    s_and_b32 s6, s5, 3
    s_lshr_b32 s7, s5, 2
    v_cndmask_b32 v130, v131, v130, vcc
    buffer_load_dwordx4 v[136:139], v130, s[8:11], s86 offen
    s_mov_b32 s65, 0x3f803f80
    s_mov_b32 s100, 0
    s_lshl_b32 s67, s7, 1
    s_xor_b32 s67, s67, s6
    s_mov_b32 s40, s70
    s_add_u32 s71, s70, 1
    s_cmp_eq_u32 s71, 7
    s_cselect_b32 s71, 0, s71
    s_add_u32 s72, s71, 1
    s_cmp_eq_u32 s72, 7
    s_cselect_b32 s72, 0, s72
    s_add_u32 s73, s72, 1
    s_cmp_eq_u32 s73, 7
    s_cselect_b32 s73, 0, s73
    s_add_u32 s74, s73, 1
    s_cmp_eq_u32 s74, 7
    s_cselect_b32 s74, 0, s74
    s_add_u32 s75, s74, 1
    s_cmp_eq_u32 s75, 7
    s_cselect_b32 s75, 0, s75
    s_add_u32 s76, s75, 1
    s_cmp_eq_u32 s76, 7
    s_cselect_b32 s76, 0, s76
    s_mov_b32 s26, 1605632
    s_mov_b32 s27, 0x00020000
    s_mov_b32 s30, 401408
    s_mov_b32 s31, 0x00020000
    s_mov_b32 s34, 1835008
    s_mov_b32 s35, 0x00020000
    s_mov_b32 s38, 35651584
    s_mov_b32 s39, 0x00020000
    s_getpc_b64 s[86:87]
pc_10:
    s_add_u32 s86, s86, recurrent_scan__sliding_block__geglu_ffn__prompt_kernel-pc_10
    s_addc_u32 s87, s87, -1
    s_and_b32 s88, s2, 0x38
    s_lshl_b32 s88, s88, 10
    s_add_u32 s88, s88, s66
    s_min_u32 s88, s88, L_codeend-recurrent_scan__sliding_block__geglu_ffn__prompt_kernel-1024
    v_lshlrev_b32 v130, 4, v1
    v_add_u32 v130, s88, v130
    global_load_dwordx4 v[140:143], v130, s[86:87]
    s_add_u32 m0, s66, 114688
    s_lshl_b32 s82, s71, 7
    buffer_load_dwordx4 v2, s[8:11], s82 offen lds
    s_add_u32 m0, s66, 122880
    s_lshl_b32 s82, s71, 7
    s_add_u32 s82, s82, 57344
    buffer_load_dwordx4 v2, s[8:11], s82 offen lds
    s_add_u32 m0, s81, 32768
    s_mul_i32 s82, s71, 172032
    buffer_load_dwordx4 v3, s[12:15], s82 offen lds
    s_add_u32 m0, s81, 33792
    s_mul_i32 s82, s71, 172032
    buffer_load_dwordx4 v4, s[12:15], s82 offen lds
    s_add_u32 m0, s81, 34816
    s_mul_i32 s82, s71, 172032
    s_add_u32 s82, s82, 10752
    buffer_load_dwordx4 v3, s[12:15], s82 offen lds
    s_add_u32 m0, s81, 35840
    s_mul_i32 s82, s71, 172032
    s_add_u32 s82, s82, 10752
    buffer_load_dwordx4 v4, s[12:15], s82 offen lds
    v_and_b32 v130, 31, v1
    v_lshrrev_b32 v131, 5, v1
    v_bfe_u32 v132, v1, 1, 3
    v_xor_b32 v132, v132, v131
    s_lshl_b32 s82, s6, 12
    v_lshlrev_b32 v130, 7, v130
    v_add_u32 v130, s82, v130
    v_lshl_add_u32 v6, v132, 4, v130
    s_lshl_b32 s82, s67, 5
    v_xor_b32 v6, s82, v6
    v_xor_b32 v7, 32, v6
    v_xor_b32 v8, 64, v6
    v_xor_b32 v9, 96, v6
    v_bfe_u32 v130, v1, 2, 2
    v_lshrrev_b32 v131, 5, v1
    v_lshl_add_u32 v131, v131, 3, v130
    v_lshlrev_b32 v131, 9, v131
    v_and_b32 v132, 3, v1
    v_lshl_add_u32 v131, v132, 3, v131
    v_bfe_u32 v133, v1, 4, 1
    v_lshl_add_u32 v131, v133, 5, v131
    s_lshl_b32 s82, s67, 13
    v_xor_b32 v131, s82, v131
    s_sub_u32 s83, s4, 14
    s_lshl_b32 s84, s7, 2
    s_add_u32 s83, s83, s84
    s_add_u32 s84, s83, 0
    s_min_u32 s84, s84, 7
    v_xor_b32 v132, s84, v130
    v_lshl_add_u32 v10, v132, 6, v131
    s_add_u32 s84, s83, 1
    s_min_u32 s84, s84, 7
    v_xor_b32 v132, s84, v130
    v_lshl_add_u32 v11, v132, 6, v131
    s_add_u32 s84, s83, 2
    s_min_u32 s84, s84, 7
    v_xor_b32 v132, s84, v130
    v_lshl_add_u32 v12, v132, 6, v131
    s_add_u32 s84, s83, 3
    s_min_u32 s84, s84, 7
    v_xor_b32 v132, s84, v130
    v_lshl_add_u32 v5, v132, 6, v131
    s_waitcnt lgkmcnt(0)
    s_add_u32 s64, s64, 0x3c6ef35f
    v_add_u32 v6, 0x18000, v6
    v_add_u32 v7, 0x18000, v7
    v_add_u32 v8, 0x18000, v8
    v_add_u32 v9, 0x18000, v9
    s_waitcnt vmcnt(8)
    s_barrier
    ds_read_b64_tr_b16 v[160:161], v10 offset:0
    ds_read_b64_tr_b16 v[162:163], v10 offset:2048
    ds_read_b128 v[144:147], v6 offset:0
    ds_read_b64_tr_b16 v[164:165], v11 offset:0
    ds_read_b64_tr_b16 v[166:167], v11 offset:2048
    ds_read_b64_tr_b16 v[168:169], v12 offset:0
    ds_read_b64_tr_b16 v[170:171], v12 offset:2048
    ds_read_b64_tr_b16 v[172:173], v5 offset:0
    ds_read_b64_tr_b16 v[174:175], v5 offset:2048
    v_xor_b32 v10, 8192, v10
    ds_read_b64_tr_b16 v[176:177], v10 offset:0
    ds_read_b64_tr_b16 v[178:179], v10 offset:2048
    ds_read_b128 v[148:151], v7 offset:0
    v_xor_b32 v11, 8192, v11
    ds_read_b64_tr_b16 v[180:181], v11 offset:0
    ds_read_b64_tr_b16 v[182:183], v11 offset:2048
    v_xor_b32 v12, 8192, v12
    ds_read_b64_tr_b16 v[184:185], v12 offset:0
    s_waitcnt lgkmcnt(14)
    ds_read_b64_tr_b16 v[186:187], v12 offset:2048
    v_xor_b32 v5, 8192, v5
    s_waitcnt lgkmcnt(14)
    ds_read_b64_tr_b16 v[188:189], v5 offset:0
    s_waitcnt lgkmcnt(14)
    ds_read_b64_tr_b16 v[190:191], v5 offset:2048
    s_waitcnt lgkmcnt(9)
    v_mfma_f32_32x32x16_bf16 v[52:67], v[144:147], v[160:163], 0
    s_add_u32 m0, s66, 131072
    s_lshl_b32 s82, s72, 7
    buffer_load_dwordx4 v2, s[8:11], s82 offen lds
    v_xor_b32 v10, 24576, v10
    ds_read_b64_tr_b16 v[192:193], v10 offset:0
    ds_read_b64_tr_b16 v[194:195], v10 offset:2048
    ds_read_b128 v[152:155], v8 offset:0
    v_mfma_f32_32x32x16_bf16 v[68:83], v[144:147], v[164:167], 0
    s_add_u32 m0, s66, 139264
    s_lshl_b32 s82, s72, 7
    s_add_u32 s82, s82, 57344
    buffer_load_dwordx4 v2, s[8:11], s82 offen lds
    v_xor_b32 v11, 24576, v11
    ds_read_b64_tr_b16 v[196:197], v11 offset:0
    ds_read_b64_tr_b16 v[198:199], v11 offset:2048
    v_mfma_f32_32x32x16_bf16 v[84:99], v[144:147], v[168:171], 0
    s_waitcnt vmcnt(9)
    v_lshlrev_b32 v124, 16, v136
    v_and_b32 v125, 0xffff0000, v136
    v_lshlrev_b32 v126, 16, v137
    s_add_u32 m0, s81, 65536
    s_mul_i32 s82, s72, 172032
    buffer_load_dwordx4 v3, s[12:15], s82 offen lds
    v_xor_b32 v12, 24576, v12
    ds_read_b64_tr_b16 v[200:201], v12 offset:0
    s_waitcnt lgkmcnt(14)
    ds_read_b64_tr_b16 v[202:203], v12 offset:2048
    s_cmp_eq_u32 s7, 1
    s_cbranch_scc1 sk_11
    v_mfma_f32_32x32x16_bf16 v[100:115], v[144:147], v[172:175], 0
sk_11:
    v_xor_b32 v5, 24576, v5
    s_waitcnt lgkmcnt(14)
    ds_read_b64_tr_b16 v[204:205], v5 offset:0
    s_waitcnt lgkmcnt(14)
    ds_read_b64_tr_b16 v[206:207], v5 offset:2048
    v_mov_b32 v13, 0
    v_mov_b32 v14, 0
    v_mov_b32 v15, 0
    v_mov_b32 v16, 0
    v_dot2c_f32_bf16 v13, s65, v160
    v_dot2c_f32_bf16 v14, s65, v164
    v_dot2c_f32_bf16 v15, s65, v168
    v_dot2c_f32_bf16 v16, s65, v172
    v_dot2c_f32_bf16 v13, s65, v161
    v_dot2c_f32_bf16 v14, s65, v165
    v_dot2c_f32_bf16 v15, s65, v169
    v_dot2c_f32_bf16 v16, s65, v173
    v_dot2c_f32_bf16 v13, s65, v162
    v_dot2c_f32_bf16 v14, s65, v166
    v_dot2c_f32_bf16 v15, s65, v170
    v_dot2c_f32_bf16 v16, s65, v174
    v_dot2c_f32_bf16 v13, s65, v163
    v_dot2c_f32_bf16 v14, s65, v167
    v_dot2c_f32_bf16 v15, s65, v171
    v_dot2c_f32_bf16 v16, s65, v175
    s_waitcnt lgkmcnt(9)
    v_mfma_f32_32x32x16_bf16 v[52:67], v[148:151], v[176:179], v[52:67]
    v_and_b32 v127, 0xffff0000, v137
    v_lshlrev_b32 v128, 16, v138
    v_and_b32 v129, 0xffff0000, v138
    s_add_u32 m0, s81, 66560
    s_mul_i32 s82, s72, 172032
    buffer_load_dwordx4 v4, s[12:15], s82 offen lds
    v_xor_b32 v10, 8192, v10
    ds_read_b64_tr_b16 v[160:161], v10 offset:0
    ds_read_b64_tr_b16 v[162:163], v10 offset:2048
    ds_read_b128 v[144:147], v9 offset:0
    v_xor_b32 v11, 8192, v11
    ds_read_b64_tr_b16 v[164:165], v11 offset:0
    ds_read_b64_tr_b16 v[166:167], v11 offset:2048
    v_xor_b32 v12, 8192, v12
    ds_read_b64_tr_b16 v[168:169], v12 offset:0
    s_waitcnt lgkmcnt(14)
    ds_read_b64_tr_b16 v[170:171], v12 offset:2048
    v_xor_b32 v5, 8192, v5
    s_waitcnt lgkmcnt(14)
    ds_read_b64_tr_b16 v[172:173], v5 offset:0
    s_waitcnt lgkmcnt(14)
    ds_read_b64_tr_b16 v[174:175], v5 offset:2048
    v_mfma_f32_32x32x16_bf16 v[68:83], v[148:151], v[180:183], v[68:83]
    v_lshlrev_b32 v130, 16, v139
    v_and_b32 v131, 0xffff0000, v139
    s_add_u32 m0, s81, 67584
    s_mul_i32 s82, s72, 172032
    s_add_u32 s82, s82, 10752
    buffer_load_dwordx4 v3, s[12:15], s82 offen lds
    s_xor_b32 s82, s67, 3
    s_mul_i32 s82, s82, 8192
    s_lshl_b32 s83, s67, 5
    v_xor_b32 v10, s82, v10
    v_xor_b32 v11, s82, v11
    v_xor_b32 v12, s82, v12
    v_xor_b32 v5, s82, v5
    v_xor_b32 v6, s83, v6
    v_xor_b32 v7, s83, v7
    v_xor_b32 v8, s83, v8
    v_xor_b32 v9, s83, v9
    v_mfma_f32_32x32x16_bf16 v[84:99], v[148:151], v[184:187], v[84:99]
    v_add_f32 v132, v124, v125
    v_add_f32 v133, v126, v127
    v_add_f32 v134, v128, v129
    s_add_u32 m0, s81, 68608
    s_mul_i32 s82, s72, 172032
    s_add_u32 s82, s82, 10752
    buffer_load_dwordx4 v4, s[12:15], s82 offen lds
    s_cmp_eq_u32 s7, 1
    s_cbranch_scc1 sk_12
    v_mfma_f32_32x32x16_bf16 v[100:115], v[148:151], v[188:191], v[100:115]
sk_12:
    s_waitcnt vmcnt(6)
    s_waitcnt lgkmcnt(0)
    s_barrier
    v_mfma_f32_32x32x16_bf16 v[52:67], v[152:155], v[192:195], v[52:67]
    v_add_f32 v135, v130, v131
    v_add_f32 v132, v132, v133
    s_mul_i32 s82, s7, 4
    s_lshl_b32 s83, s6, 3
    s_add_u32 s82, s82, s83
    s_lshl_b32 s82, s82, 7
    s_add_u32 s82, s82, 159744
    v_and_b32 v17, 31, v1
    v_lshlrev_b32 v17, 2, v17
    v_add_u32 v17, s82, v17
    v_mov_b32 v18, v13
    s_nop 1
    v_permlane32_swap_b32 v18, v13
    ds_read_b64_tr_b16 v[176:177], v10 offset:32768
    ds_read_b64_tr_b16 v[178:179], v10 offset:34816
    ds_read_b128 v[148:151], v6 offset:16384
    v_mfma_f32_32x32x16_bf16 v[68:83], v[152:155], v[196:199], v[68:83]
    v_add_f32 v134, v134, v135
    v_add_f32 v132, v132, v134
    s_nop 1
    v_add_f32_dpp v132, v132, v132 row_shr:1 row_mask:0xf bank_mask:0xf bound_ctrl:0
    v_add_f32 v13, v18, v13
    ds_write_b32 v17, v13 offset:0
    ds_read_b64_tr_b16 v[180:181], v11 offset:32768
    ds_read_b64_tr_b16 v[182:183], v11 offset:34816
    v_mfma_f32_32x32x16_bf16 v[84:99], v[152:155], v[200:203], v[84:99]
    v_add_f32_dpp v132, v132, v132 row_shr:2 row_mask:0xf bank_mask:0xf bound_ctrl:0
    s_nop 1
    v_add_f32_dpp v132, v132, v132 row_shr:4 row_mask:0xf bank_mask:0xf bound_ctrl:0
    v_mov_b32 v18, v14
    s_nop 1
    v_permlane32_swap_b32 v18, v14
    ds_read_b64_tr_b16 v[184:185], v12 offset:32768
    ds_read_b64_tr_b16 v[186:187], v12 offset:34816
    s_cmp_eq_u32 s7, 1
    s_cbranch_scc1 sk_13
    v_mfma_f32_32x32x16_bf16 v[100:115], v[152:155], v[204:207], v[100:115]
sk_13:
    ds_read_b64_tr_b16 v[188:189], v5 offset:32768
    ds_read_b64_tr_b16 v[190:191], v5 offset:34816
    v_mfma_f32_32x32x16_bf16 v[52:67], v[144:147], v[160:163], v[52:67]
    v_add_f32_dpp v132, v132, v132 row_shr:8 row_mask:0xf bank_mask:0xf bound_ctrl:0
    s_nop 1
    v_add_f32_dpp v132, v132, v132 row_bcast:15 row_mask:0xa bank_mask:0xf
    s_nop 1
    v_add_f32_dpp v132, v132, v132 row_bcast:31 row_mask:0xc bank_mask:0xf
    v_add_f32 v14, v18, v14
    ds_write_b32 v17, v14 offset:128
    v_mov_b32 v18, v15
    ds_read_b64_tr_b16 v[192:193], v10 offset:40960
    ds_read_b64_tr_b16 v[194:195], v10 offset:43008
    ds_read_b128 v[152:155], v7 offset:16384
    v_mfma_f32_32x32x16_bf16 v[68:83], v[144:147], v[164:167], v[68:83]
    v_readlane_b32 s90, v132, 63
    v_mov_b32 v133, 0x3b124925
    v_permlane32_swap_b32 v18, v15
    v_add_f32 v15, v18, v15
    ds_read_b64_tr_b16 v[196:197], v11 offset:40960
    s_waitcnt lgkmcnt(14)
    ds_read_b64_tr_b16 v[198:199], v11 offset:43008
    v_mfma_f32_32x32x16_bf16 v[84:99], v[144:147], v[168:171], v[84:99]
    v_mul_f32 v133, s90, v133
    v_cmp_gt_u32 s[92:93], 56, v1
    v_mov_b32 v132, 0
    s_waitcnt lgkmcnt(14)
    ds_write_b32 v17, v15 offset:256
    v_mov_b32 v18, v16
    s_waitcnt lgkmcnt(14)
    ds_read_b64_tr_b16 v[200:201], v12 offset:40960
    s_waitcnt lgkmcnt(14)
    ds_read_b64_tr_b16 v[202:203], v12 offset:43008
    s_cmp_eq_u32 s7, 1
    s_cbranch_scc1 sk_14
    v_mfma_f32_32x32x16_bf16 v[100:115], v[144:147], v[172:175], v[100:115]
sk_14:
    s_waitcnt lgkmcnt(14)
    ds_read_b64_tr_b16 v[204:205], v5 offset:40960
    s_waitcnt lgkmcnt(14)
    ds_read_b64_tr_b16 v[206:207], v5 offset:43008
    s_waitcnt lgkmcnt(11)
    v_mfma_f32_32x32x16_bf16 v[52:67], v[148:151], v[176:179], v[52:67]
    v_cndmask_b32 v134, 0, v133, s[92:93]
    v_sub_f32 v124, v124, v134
    v_permlane32_swap_b32 v18, v16
    v_add_f32 v16, v18, v16
    ds_write_b32 v17, v16 offset:384
    ds_read_b64_tr_b16 v[160:161], v10 offset:49152
    ds_read_b64_tr_b16 v[162:163], v10 offset:51200
    ds_read_b128 v[144:147], v8 offset:16384
    v_mfma_f32_32x32x16_bf16 v[68:83], v[148:151], v[180:183], v[68:83]
    v_sub_f32 v125, v125, v134
    v_sub_f32 v126, v126, v134
    v_sub_f32 v127, v127, v134
    s_add_u32 m0, s66, 98304
    s_lshl_b32 s82, s73, 7
    buffer_load_dwordx4 v2, s[8:11], s82 offen lds
    s_add_u32 m0, s66, 106496
    s_lshl_b32 s82, s73, 7
    s_add_u32 s82, s82, 57344
    buffer_load_dwordx4 v2, s[8:11], s82 offen lds
    s_waitcnt lgkmcnt(14)
    ds_read_b64_tr_b16 v[164:165], v11 offset:49152
    s_waitcnt lgkmcnt(14)
    ds_read_b64_tr_b16 v[166:167], v11 offset:51200
    v_mfma_f32_32x32x16_bf16 v[84:99], v[148:151], v[184:187], v[84:99]
    v_sub_f32 v128, v128, v134
    v_sub_f32 v129, v129, v134
    v_sub_f32 v130, v130, v134
    s_add_u32 m0, s81, 0
    s_mul_i32 s82, s73, 172032
    buffer_load_dwordx4 v3, s[12:15], s82 offen lds
    s_add_u32 m0, s81, 1024
    s_mul_i32 s82, s73, 172032
    buffer_load_dwordx4 v4, s[12:15], s82 offen lds
    s_waitcnt lgkmcnt(14)
    ds_read_b64_tr_b16 v[168:169], v12 offset:49152
    s_waitcnt lgkmcnt(14)
    ds_read_b64_tr_b16 v[170:171], v12 offset:51200
    s_cmp_eq_u32 s7, 1
    s_cbranch_scc1 sk_15
    v_mfma_f32_32x32x16_bf16 v[100:115], v[148:151], v[188:191], v[100:115]
sk_15:
    s_waitcnt lgkmcnt(14)
    ds_read_b64_tr_b16 v[172:173], v5 offset:49152
    s_waitcnt lgkmcnt(14)
    ds_read_b64_tr_b16 v[174:175], v5 offset:51200
    s_waitcnt lgkmcnt(10)
    v_mfma_f32_32x32x16_bf16 v[52:67], v[152:155], v[192:195], v[52:67]
    v_sub_f32 v131, v131, v134
    v_mul_f32 v135, v124, v124
    s_add_u32 m0, s81, 2048
    s_mul_i32 s82, s73, 172032
    s_add_u32 s82, s82, 10752
    buffer_load_dwordx4 v3, s[12:15], s82 offen lds
    s_add_u32 m0, s81, 3072
    s_mul_i32 s82, s73, 172032
    s_add_u32 s82, s82, 10752
    buffer_load_dwordx4 v4, s[12:15], s82 offen lds
    ds_read_b64_tr_b16 v[176:177], v10 offset:57344
    ds_read_b64_tr_b16 v[178:179], v10 offset:59392
    ds_read_b128 v[148:151], v9 offset:16384
    ds_read_b64_tr_b16 v[180:181], v11 offset:57344
    ds_read_b64_tr_b16 v[182:183], v11 offset:59392
    s_waitcnt lgkmcnt(14)
    ds_read_b64_tr_b16 v[184:185], v12 offset:57344
    s_waitcnt lgkmcnt(14)
    ds_read_b64_tr_b16 v[186:187], v12 offset:59392
    s_waitcnt lgkmcnt(14)
    ds_read_b64_tr_b16 v[188:189], v5 offset:57344
    s_waitcnt lgkmcnt(14)
    ds_read_b64_tr_b16 v[190:191], v5 offset:59392
    v_mfma_f32_32x32x16_bf16 v[68:83], v[152:155], v[196:199], v[68:83]
    v_fmac_f32 v132, v125, v125
    v_fmac_f32 v135, v126, v126
    v_fmac_f32 v132, v127, v127
    v_add_u32 v10, 0x10000, v10
    v_add_u32 v11, 0x10000, v11
    v_add_u32 v12, 0x10000, v12
    v_add_u32 v5, 0x10000, v5
    v_mfma_f32_32x32x16_bf16 v[84:99], v[152:155], v[200:203], v[84:99]
    v_fmac_f32 v135, v128, v128
    v_fmac_f32 v132, v129, v129
    s_cmp_eq_u32 s7, 1
    s_cbranch_scc1 sk_16
    v_mfma_f32_32x32x16_bf16 v[100:115], v[152:155], v[204:207], v[100:115]
sk_16:
    s_waitcnt vmcnt(6)
    s_waitcnt lgkmcnt(0)
    s_barrier
    v_mfma_f32_32x32x16_bf16 v[52:67], v[144:147], v[160:163], v[52:67]
    v_fmac_f32 v135, v130, v130
    v_fmac_f32 v132, v131, v131
    v_add_f32 v132, v132, v135
    s_add_u32 m0, s66, 114688
    s_lshl_b32 s82, s74, 7
    buffer_load_dwordx4 v2, s[8:11], s82 offen lds
    ds_read_b64_tr_b16 v[192:193], v10 offset:0
    ds_read_b64_tr_b16 v[194:195], v10 offset:2048
    ds_read_b128 v[152:155], v6 offset:32768
    v_mfma_f32_32x32x16_bf16 v[68:83], v[144:147], v[164:167], v[68:83]
    v_add_f32_dpp v132, v132, v132 row_shr:1 row_mask:0xf bank_mask:0xf bound_ctrl:0
    s_nop 1
    v_add_f32_dpp v132, v132, v132 row_shr:2 row_mask:0xf bank_mask:0xf bound_ctrl:0
    s_add_u32 m0, s66, 122880
    s_lshl_b32 s82, s74, 7
    s_add_u32 s82, s82, 57344
    buffer_load_dwordx4 v2, s[8:11], s82 offen lds
    ds_read_b64_tr_b16 v[196:197], v11 offset:0
    ds_read_b64_tr_b16 v[198:199], v11 offset:2048
    v_mfma_f32_32x32x16_bf16 v[84:99], v[144:147], v[168:171], v[84:99]
    v_add_f32_dpp v132, v132, v132 row_shr:4 row_mask:0xf bank_mask:0xf bound_ctrl:0
    s_nop 1
    v_add_f32_dpp v132, v132, v132 row_shr:8 row_mask:0xf bank_mask:0xf bound_ctrl:0
    s_nop 1
    v_add_f32_dpp v132, v132, v132 row_bcast:15 row_mask:0xa bank_mask:0xf
    ds_read_b64_tr_b16 v[200:201], v12 offset:0
    ds_read_b64_tr_b16 v[202:203], v12 offset:2048
    s_cmp_eq_u32 s7, 1
    s_cbranch_scc1 sk_17
    v_mfma_f32_32x32x16_bf16 v[100:115], v[144:147], v[172:175], v[100:115]
sk_17:
    ds_read_b64_tr_b16 v[204:205], v5 offset:0
    ds_read_b64_tr_b16 v[206:207], v5 offset:2048
    v_mfma_f32_32x32x16_bf16 v[52:67], v[148:151], v[176:179], v[52:67]
    v_add_f32_dpp v132, v132, v132 row_bcast:31 row_mask:0xc bank_mask:0xf
    s_nop 0
    v_readlane_b32 s90, v132, 63
    s_add_u32 m0, s81, 32768
    s_mul_i32 s82, s74, 172032
    buffer_load_dwordx4 v3, s[12:15], s82 offen lds
    ds_read_b64_tr_b16 v[160:161], v10 offset:8192
    ds_read_b64_tr_b16 v[162:163], v10 offset:10240
    ds_read_b128 v[144:147], v7 offset:32768
    v_mfma_f32_32x32x16_bf16 v[68:83], v[148:151], v[180:183], v[68:83]
    v_mov_b32 v134, 0x3b124925
    v_mov_b32 v126, 0x3727c5ac
    v_fmac_f32 v126, s90, v134
    ds_read_b64_tr_b16 v[164:165], v11 offset:8192
    ds_read_b64_tr_b16 v[166:167], v11 offset:10240
    v_mfma_f32_32x32x16_bf16 v[84:99], v[148:151], v[184:187], v[84:99]
    v_cmp_eq_u32 s[92:93], 0, v1
    v_rsq_f32 v124, v126
    s_add_u32 m0, s81, 33792
    s_mul_i32 s82, s74, 172032
    buffer_load_dwordx4 v4, s[12:15], s82 offen lds
    ds_read_b64_tr_b16 v[168:169], v12 offset:8192
    s_waitcnt lgkmcnt(14)
    ds_read_b64_tr_b16 v[170:171], v12 offset:10240
    s_cmp_eq_u32 s7, 1
    s_cbranch_scc1 sk_18
    v_mfma_f32_32x32x16_bf16 v[100:115], v[148:151], v[188:191], v[100:115]
sk_18:
    s_waitcnt lgkmcnt(14)
    ds_read_b64_tr_b16 v[172:173], v5 offset:8192
    s_waitcnt lgkmcnt(14)
    ds_read_b64_tr_b16 v[174:175], v5 offset:10240
    s_waitcnt lgkmcnt(9)
    v_mfma_f32_32x32x16_bf16 v[52:67], v[152:155], v[192:195], v[52:67]
    v_mov_b32 v125, v133
    v_mov_b32 v127, s64
    v_mov_b32 v128, 0x7ffffff0
    s_add_u32 m0, s81, 34816
    s_mul_i32 s82, s74, 172032
    s_add_u32 s82, s82, 10752
    buffer_load_dwordx4 v3, s[12:15], s82 offen lds
    v_and_b32 v17, 0xff, v0
    v_lshlrev_b32 v17, 2, v17
    ds_read_b64_tr_b16 v[176:177], v10 offset:16384
    ds_read_b64_tr_b16 v[178:179], v10 offset:18432
    ds_read_b128 v[148:151], v8 offset:32768
    v_mfma_f32_32x32x16_bf16 v[68:83], v[152:155], v[196:199], v[68:83]
    v_cndmask_b32 v128, v128, 0, s[92:93]
    buffer_store_dwordx4 v[124:127], v128, s[36:39], s68 offen sc1
    v_add_u32 v18, 159744, v17
    ds_read_b64_tr_b16 v[180:181], v11 offset:16384
    ds_read_b64_tr_b16 v[182:183], v11 offset:18432
    v_mfma_f32_32x32x16_bf16 v[84:99], v[152:155], v[200:203], v[84:99]
    s_add_u32 m0, s81, 35840
    s_mul_i32 s82, s74, 172032
    s_add_u32 s82, s82, 10752
    buffer_load_dwordx4 v4, s[12:15], s82 offen lds
    ds_read_b32 v140, v18
    s_waitcnt lgkmcnt(14)
    ds_read_b32 v141, v18 offset:1024
    s_waitcnt lgkmcnt(14)
    ds_read_b64_tr_b16 v[184:185], v12 offset:16384
    s_waitcnt lgkmcnt(14)
    ds_read_b64_tr_b16 v[186:187], v12 offset:18432
    s_cmp_eq_u32 s7, 1
    s_cbranch_scc1 sk_19
    v_mfma_f32_32x32x16_bf16 v[100:115], v[152:155], v[204:207], v[100:115]
sk_19:
    s_waitcnt lgkmcnt(14)
    ds_read_b64_tr_b16 v[188:189], v5 offset:16384
    s_waitcnt lgkmcnt(14)
    ds_read_b64_tr_b16 v[190:191], v5 offset:18432
    s_waitcnt lgkmcnt(11)
    v_mfma_f32_32x32x16_bf16 v[52:67], v[144:147], v[160:163], v[52:67]
    ds_read_b32 v142, v18 offset:2048
    ds_read_b64_tr_b16 v[192:193], v10 offset:24576
    ds_read_b64_tr_b16 v[194:195], v10 offset:26624
    ds_read_b128 v[152:155], v9 offset:32768
    s_waitcnt lgkmcnt(14)
    ds_read_b64_tr_b16 v[196:197], v11 offset:24576
    s_waitcnt lgkmcnt(14)
    ds_read_b64_tr_b16 v[198:199], v11 offset:26624
    s_waitcnt lgkmcnt(14)
    ds_read_b64_tr_b16 v[200:201], v12 offset:24576
    s_waitcnt lgkmcnt(14)
    ds_read_b64_tr_b16 v[202:203], v12 offset:26624
    s_waitcnt lgkmcnt(14)
    ds_read_b64_tr_b16 v[204:205], v5 offset:24576
    s_waitcnt lgkmcnt(14)
    ds_read_b64_tr_b16 v[206:207], v5 offset:26624
    v_mfma_f32_32x32x16_bf16 v[68:83], v[144:147], v[164:167], v[68:83]
    s_waitcnt lgkmcnt(14)
    ds_read_b32 v143, v18 offset:3072
    v_lshlrev_b32 v17, 1, v17
    v_add_u32 v10, 0xffff0000, v10
    v_add_u32 v11, 0xffff0000, v11
    v_add_u32 v12, 0xffff0000, v12
    v_add_u32 v5, 0xffff0000, v5
    v_mfma_f32_32x32x16_bf16 v[84:99], v[144:147], v[168:171], v[84:99]
    s_lshl_b32 s82, s4, 5
    s_add_u32 s82, s82, s40
    s_lshl_b32 s82, s82, 11
    s_add_u32 s82, s82, 19922944
    s_cmp_lt_u32 s5, 4
    s_cselect_b32 s82, s82, 0x7ffffff0
    v_add_f32 v140, v140, v141
    s_waitcnt lgkmcnt(0)
    v_add_f32 v142, v142, v143
    v_mov_b32 v141, s64
    v_add_f32 v140, v140, v142
    buffer_store_dwordx2 v[140:141], v17, s[36:39], s82 offen sc1
    s_cmp_eq_u32 s7, 1
    s_cbranch_scc1 sk_20
    v_mfma_f32_32x32x16_bf16 v[100:115], v[144:147], v[172:175], v[100:115]
sk_20:
    s_waitcnt vmcnt(8)
    s_barrier
    v_mfma_f32_32x32x16_bf16 v[52:67], v[148:151], v[176:179], v[52:67]
    s_add_u32 m0, s66, 131072
    s_lshl_b32 s82, s75, 7
    buffer_load_dwordx4 v2, s[8:11], s82 offen lds
    ds_read_b64_tr_b16 v[160:161], v10 offset:0
    ds_read_b64_tr_b16 v[162:163], v10 offset:2048
    ds_read_b128 v[144:147], v6 offset:0
    v_mfma_f32_32x32x16_bf16 v[68:83], v[148:151], v[180:183], v[68:83]
    s_add_u32 m0, s66, 139264
    s_lshl_b32 s82, s75, 7
    s_add_u32 s82, s82, 57344
    buffer_load_dwordx4 v2, s[8:11], s82 offen lds
    ds_read_b64_tr_b16 v[164:165], v11 offset:0
    ds_read_b64_tr_b16 v[166:167], v11 offset:2048
    v_mfma_f32_32x32x16_bf16 v[84:99], v[148:151], v[184:187], v[84:99]
    ds_read_b64_tr_b16 v[168:169], v12 offset:0
    ds_read_b64_tr_b16 v[170:171], v12 offset:2048
    s_cmp_eq_u32 s7, 1
    s_cbranch_scc1 sk_21
    v_mfma_f32_32x32x16_bf16 v[100:115], v[148:151], v[188:191], v[100:115]
sk_21:
    ds_read_b64_tr_b16 v[172:173], v5 offset:0
    ds_read_b64_tr_b16 v[174:175], v5 offset:2048
    v_mfma_f32_32x32x16_bf16 v[52:67], v[152:155], v[192:195], v[52:67]
    s_add_u32 m0, s81, 65536
    s_mul_i32 s82, s75, 172032
    buffer_load_dwordx4 v3, s[12:15], s82 offen lds
    ds_read_b64_tr_b16 v[176:177], v10 offset:8192
    ds_read_b64_tr_b16 v[178:179], v10 offset:10240
    ds_read_b128 v[148:151], v7 offset:0
    v_mfma_f32_32x32x16_bf16 v[68:83], v[152:155], v[196:199], v[68:83]
    ds_read_b64_tr_b16 v[180:181], v11 offset:8192
    ds_read_b64_tr_b16 v[182:183], v11 offset:10240
    v_mfma_f32_32x32x16_bf16 v[84:99], v[152:155], v[200:203], v[84:99]
    s_add_u32 m0, s81, 66560
    s_mul_i32 s82, s75, 172032
    buffer_load_dwordx4 v4, s[12:15], s82 offen lds
    ds_read_b64_tr_b16 v[184:185], v12 offset:8192
    s_waitcnt lgkmcnt(14)
    ds_read_b64_tr_b16 v[186:187], v12 offset:10240
    s_cmp_eq_u32 s7, 1
    s_cbranch_scc1 sk_22
    v_mfma_f32_32x32x16_bf16 v[100:115], v[152:155], v[204:207], v[100:115]
sk_22:
    s_waitcnt lgkmcnt(14)
    ds_read_b64_tr_b16 v[188:189], v5 offset:8192
    s_waitcnt lgkmcnt(14)
    ds_read_b64_tr_b16 v[190:191], v5 offset:10240
    s_waitcnt lgkmcnt(9)
    v_mfma_f32_32x32x16_bf16 v[52:67], v[144:147], v[160:163], v[52:67]
    s_add_u32 m0, s81, 67584
    s_mul_i32 s82, s75, 172032
    s_add_u32 s82, s82, 10752
    buffer_load_dwordx4 v3, s[12:15], s82 offen lds
    v_and_b32 v212, 31, v1
    v_lshrrev_b32 v213, 5, v1
    v_lshlrev_b32 v213, 8, v213
    v_mov_b32 v216, 0x7ffffff0
    s_sub_u32 s82, s4, 14
    s_lshl_b32 s84, s7, 7
    v_add_u32 v212, s84, v212
    s_lshl_b32 s85, s82, 13
    s_lshl_b32 s42, s3, 2
    s_add_u32 s42, s42, s6
    s_lshl_b32 s42, s42, 15
    s_add_u32 s42, s42, s85
    s_add_u32 s42, s42, 5242880
    s_movk_i32 s43, 224
    v_mul_u32_u24 v214, 2341, v212
    v_lshrrev_b32 v214, 16, v214
    v_mul_u32_u24 v215, 28, v214
    ds_read_b64_tr_b16 v[192:193], v10 offset:16384
    ds_read_b64_tr_b16 v[194:195], v10 offset:18432
    ds_read_b128 v[152:155], v8 offset:0
    v_mfma_f32_32x32x16_bf16 v[68:83], v[144:147], v[164:167], v[68:83]
    v_sub_u32 v215, v212, v215
    v_lshl_add_u32 v214, v214, 10, v213
    v_lshrrev_b32 v217, 4, v215
    v_and_b32 v215, 15, v215
    v_lshl_add_u32 v214, v217, 14, v214
    v_lshl_add_u32 v214, v215, 4, v214
    v_cmp_gt_u32 vcc, s43, v212
    v_add_u32 v212, 32, v212
    s_nop 0
    v_cndmask_b32 v208, v216, v214, vcc
    ds_read_b64_tr_b16 v[196:197], v11 offset:16384
    ds_read_b64_tr_b16 v[198:199], v11 offset:18432
    v_mfma_f32_32x32x16_bf16 v[84:99], v[144:147], v[168:171], v[84:99]
    s_add_u32 m0, s81, 68608
    s_mul_i32 s82, s75, 172032
    s_add_u32 s82, s82, 10752
    buffer_load_dwordx4 v4, s[12:15], s82 offen lds
    v_mul_u32_u24 v214, 2341, v212
    v_lshrrev_b32 v214, 16, v214
    v_mul_u32_u24 v215, 28, v214
    v_sub_u32 v215, v212, v215
    v_lshl_add_u32 v214, v214, 10, v213
    v_lshrrev_b32 v217, 4, v215
    v_and_b32 v215, 15, v215
    v_lshl_add_u32 v214, v217, 14, v214
    ds_read_b64_tr_b16 v[200:201], v12 offset:16384
    s_waitcnt lgkmcnt(14)
    ds_read_b64_tr_b16 v[202:203], v12 offset:18432
    s_cmp_eq_u32 s7, 1
    s_cbranch_scc1 sk_23
    v_mfma_f32_32x32x16_bf16 v[100:115], v[144:147], v[172:175], v[100:115]
sk_23:
    s_waitcnt lgkmcnt(14)
    ds_read_b64_tr_b16 v[204:205], v5 offset:16384
    s_waitcnt lgkmcnt(14)
    ds_read_b64_tr_b16 v[206:207], v5 offset:18432
    s_waitcnt lgkmcnt(9)
    v_mfma_f32_32x32x16_bf16 v[52:67], v[148:151], v[176:179], v[52:67]
    v_lshl_add_u32 v214, v215, 4, v214
    v_cmp_gt_u32 vcc, s43, v212
    v_add_u32 v212, 32, v212
    s_nop 0
    v_cndmask_b32 v209, v216, v214, vcc
    v_mul_u32_u24 v214, 2341, v212
    v_lshrrev_b32 v214, 16, v214
    v_mul_u32_u24 v215, 28, v214
    v_sub_u32 v215, v212, v215
    v_lshl_add_u32 v214, v214, 10, v213
    ds_read_b64_tr_b16 v[160:161], v10 offset:24576
    ds_read_b64_tr_b16 v[162:163], v10 offset:26624
    ds_read_b128 v[144:147], v9 offset:0
    ds_read_b64_tr_b16 v[164:165], v11 offset:24576
    ds_read_b64_tr_b16 v[166:167], v11 offset:26624
    ds_read_b64_tr_b16 v[168:169], v12 offset:24576
    s_waitcnt lgkmcnt(14)
    ds_read_b64_tr_b16 v[170:171], v12 offset:26624
    s_waitcnt lgkmcnt(14)
    ds_read_b64_tr_b16 v[172:173], v5 offset:24576
    s_waitcnt lgkmcnt(14)
    ds_read_b64_tr_b16 v[174:175], v5 offset:26624
    v_mfma_f32_32x32x16_bf16 v[68:83], v[148:151], v[180:183], v[68:83]
    v_lshrrev_b32 v217, 4, v215
    v_and_b32 v215, 15, v215
    v_lshl_add_u32 v214, v217, 14, v214
    v_lshl_add_u32 v214, v215, 4, v214
    v_cmp_gt_u32 vcc, s43, v212
    v_add_u32 v212, 32, v212
    s_nop 0
    v_cndmask_b32 v210, v216, v214, vcc
    v_mul_u32_u24 v214, 2341, v212
    v_lshrrev_b32 v214, 16, v214
    v_mul_u32_u24 v215, 28, v214
    v_mfma_f32_32x32x16_bf16 v[84:99], v[148:151], v[184:187], v[84:99]
    v_sub_u32 v215, v212, v215
    v_lshl_add_u32 v214, v214, 10, v213
    v_lshrrev_b32 v217, 4, v215
    v_and_b32 v215, 15, v215
    v_lshl_add_u32 v214, v217, 14, v214
    v_lshl_add_u32 v214, v215, 4, v214
    v_cmp_gt_u32 vcc, s43, v212
    v_add_u32 v212, 32, v212
    s_nop 0
    v_cndmask_b32 v211, v216, v214, vcc
    s_cmp_eq_u32 s7, 1
    s_cbranch_scc1 sk_24
    v_mfma_f32_32x32x16_bf16 v[100:115], v[148:151], v[188:191], v[100:115]
sk_24:
    s_waitcnt vmcnt(7)
    s_waitcnt lgkmcnt(0)
    s_barrier
    v_mfma_f32_32x32x16_bf16 v[52:67], v[152:155], v[192:195], v[52:67]
    s_add_u32 m0, s66, 98304
    s_lshl_b32 s82, s76, 7
    buffer_load_dwordx4 v2, s[8:11], s82 offen lds
    ds_read_b64_tr_b16 v[176:177], v10 offset:32768
    ds_read_b64_tr_b16 v[178:179], v10 offset:34816
    ds_read_b128 v[148:151], v6 offset:16384
    v_mfma_f32_32x32x16_bf16 v[68:83], v[152:155], v[196:199], v[68:83]
    s_add_u32 m0, s66, 106496
    s_lshl_b32 s82, s76, 7
    s_add_u32 s82, s82, 57344
    buffer_load_dwordx4 v2, s[8:11], s82 offen lds
    ds_read_b64_tr_b16 v[180:181], v11 offset:32768
    ds_read_b64_tr_b16 v[182:183], v11 offset:34816
    v_mfma_f32_32x32x16_bf16 v[84:99], v[152:155], v[200:203], v[84:99]
    ds_read_b64_tr_b16 v[184:185], v12 offset:32768
    ds_read_b64_tr_b16 v[186:187], v12 offset:34816
    s_cmp_eq_u32 s7, 1
    s_cbranch_scc1 sk_25
    v_mfma_f32_32x32x16_bf16 v[100:115], v[152:155], v[204:207], v[100:115]
sk_25:
    ds_read_b64_tr_b16 v[188:189], v5 offset:32768
    ds_read_b64_tr_b16 v[190:191], v5 offset:34816
    v_mfma_f32_32x32x16_bf16 v[52:67], v[144:147], v[160:163], v[52:67]
    s_add_u32 m0, s81, 0
    s_mul_i32 s82, s76, 172032
    buffer_load_dwordx4 v3, s[12:15], s82 offen lds
    ds_read_b64_tr_b16 v[192:193], v10 offset:40960
    ds_read_b64_tr_b16 v[194:195], v10 offset:43008
    ds_read_b128 v[152:155], v7 offset:16384
    v_mfma_f32_32x32x16_bf16 v[68:83], v[144:147], v[164:167], v[68:83]
    ds_read_b64_tr_b16 v[196:197], v11 offset:40960
    ds_read_b64_tr_b16 v[198:199], v11 offset:43008
    v_mfma_f32_32x32x16_bf16 v[84:99], v[144:147], v[168:171], v[84:99]
    s_add_u32 m0, s81, 1024
    s_mul_i32 s82, s76, 172032
    buffer_load_dwordx4 v4, s[12:15], s82 offen lds
    ds_read_b64_tr_b16 v[200:201], v12 offset:40960
    s_waitcnt lgkmcnt(14)
    ds_read_b64_tr_b16 v[202:203], v12 offset:43008
    s_cmp_eq_u32 s7, 1
    s_cbranch_scc1 sk_26
    v_mfma_f32_32x32x16_bf16 v[100:115], v[144:147], v[172:175], v[100:115]
sk_26:
    s_waitcnt lgkmcnt(14)
    ds_read_b64_tr_b16 v[204:205], v5 offset:40960
    s_waitcnt lgkmcnt(14)
    ds_read_b64_tr_b16 v[206:207], v5 offset:43008
    s_waitcnt lgkmcnt(9)
    v_mfma_f32_32x32x16_bf16 v[52:67], v[148:151], v[176:179], v[52:67]
    s_add_u32 m0, s81, 2048
    s_mul_i32 s82, s76, 172032
    s_add_u32 s82, s82, 10752
    buffer_load_dwordx4 v3, s[12:15], s82 offen lds
    v_lshrrev_b32 v212, 2, v1
    v_and_b32 v213, 3, v1
    ds_read_b64_tr_b16 v[160:161], v10 offset:49152
    ds_read_b64_tr_b16 v[162:163], v10 offset:51200
    ds_read_b128 v[144:147], v8 offset:16384
    v_mfma_f32_32x32x16_bf16 v[68:83], v[148:151], v[180:183], v[68:83]
    v_lshlrev_b32 v212, 8, v212
    ds_read_b64_tr_b16 v[164:165], v11 offset:49152
    ds_read_b64_tr_b16 v[166:167], v11 offset:51200
    v_mfma_f32_32x32x16_bf16 v[84:99], v[148:151], v[184:187], v[84:99]
    s_add_u32 m0, s81, 3072
    s_mul_i32 s82, s76, 172032
    s_add_u32 s82, s82, 10752
    buffer_load_dwordx4 v4, s[12:15], s82 offen lds
    v_lshl_add_u32 v212, v213, 4, v212
    v_mov_b32 v220, s65
    ds_read_b64_tr_b16 v[168:169], v12 offset:49152
    s_waitcnt lgkmcnt(14)
    ds_read_b64_tr_b16 v[170:171], v12 offset:51200
    s_cmp_eq_u32 s7, 1
    s_cbranch_scc1 sk_27
    v_mfma_f32_32x32x16_bf16 v[100:115], v[148:151], v[188:191], v[100:115]
sk_27:
    s_waitcnt lgkmcnt(14)
    ds_read_b64_tr_b16 v[172:173], v5 offset:49152
    s_waitcnt lgkmcnt(14)
    ds_read_b64_tr_b16 v[174:175], v5 offset:51200
    s_waitcnt lgkmcnt(9)
    v_mfma_f32_32x32x16_bf16 v[52:67], v[152:155], v[192:195], v[52:67]
    v_mov_b32 v221, s65
    ds_read_b64_tr_b16 v[176:177], v10 offset:57344
    ds_read_b64_tr_b16 v[178:179], v10 offset:59392
    ds_read_b128 v[148:151], v9 offset:16384
    ds_read_b64_tr_b16 v[180:181], v11 offset:57344
    ds_read_b64_tr_b16 v[182:183], v11 offset:59392
    ds_read_b64_tr_b16 v[184:185], v12 offset:57344
    s_waitcnt lgkmcnt(14)
    ds_read_b64_tr_b16 v[186:187], v12 offset:59392
    s_waitcnt lgkmcnt(14)
    ds_read_b64_tr_b16 v[188:189], v5 offset:57344
    s_waitcnt lgkmcnt(14)
    ds_read_b64_tr_b16 v[190:191], v5 offset:59392
    v_mfma_f32_32x32x16_bf16 v[68:83], v[152:155], v[196:199], v[68:83]
    v_mov_b32 v222, s65
    v_mov_b32 v223, s65
    v_add_u32 v10, 0x10000, v10
    v_add_u32 v11, 0x10000, v11
    v_add_u32 v12, 0x10000, v12
    v_add_u32 v5, 0x10000, v5
    v_mfma_f32_32x32x16_bf16 v[84:99], v[152:155], v[200:203], v[84:99]
    s_lshl_b32 s82, s7, 12
    s_add_u32 s82, s82, s42
    s_add_u32 s82, s82, 16384
    buffer_store_dwordx4 v[220:223], v212, s[36:39], s82 offen offset:192 sc1
    s_cmp_eq_u32 s7, 1
    s_cbranch_scc1 sk_28
    v_mfma_f32_32x32x16_bf16 v[100:115], v[152:155], v[204:207], v[100:115]
sk_28:
    s_waitcnt vmcnt(7)
    s_waitcnt lgkmcnt(0)
    s_barrier
    v_mfma_f32_32x32x16_bf16 v[52:67], v[144:147], v[160:163], v[52:67]
    ds_read_b64_tr_b16 v[192:193], v10 offset:0
    ds_read_b64_tr_b16 v[194:195], v10 offset:2048
    ds_read_b128 v[152:155], v6 offset:32768
    v_mfma_f32_32x32x16_bf16 v[68:83], v[144:147], v[164:167], v[68:83]
    ds_read_b64_tr_b16 v[196:197], v11 offset:0
    ds_read_b64_tr_b16 v[198:199], v11 offset:2048
    v_mfma_f32_32x32x16_bf16 v[84:99], v[144:147], v[168:171], v[84:99]
    ds_read_b64_tr_b16 v[200:201], v12 offset:0
    ds_read_b64_tr_b16 v[202:203], v12 offset:2048
    s_cmp_eq_u32 s7, 1
    s_cbranch_scc1 sk_30
    v_mfma_f32_32x32x16_bf16 v[100:115], v[144:147], v[172:175], v[100:115]
sk_30:
    ds_read_b64_tr_b16 v[204:205], v5 offset:0
    ds_read_b64_tr_b16 v[206:207], v5 offset:2048
    v_mfma_f32_32x32x16_bf16 v[52:67], v[148:151], v[176:179], v[52:67]
    ds_read_b64_tr_b16 v[160:161], v10 offset:8192
    ds_read_b64_tr_b16 v[162:163], v10 offset:10240
    ds_read_b128 v[144:147], v7 offset:32768
    v_mfma_f32_32x32x16_bf16 v[68:83], v[148:151], v[180:183], v[68:83]
    ds_read_b64_tr_b16 v[164:165], v11 offset:8192
    ds_read_b64_tr_b16 v[166:167], v11 offset:10240
    v_mfma_f32_32x32x16_bf16 v[84:99], v[148:151], v[184:187], v[84:99]
    ds_read_b64_tr_b16 v[168:169], v12 offset:8192
    s_waitcnt lgkmcnt(14)
    ds_read_b64_tr_b16 v[170:171], v12 offset:10240
    s_cmp_eq_u32 s7, 1
    s_cbranch_scc1 sk_31
    v_mfma_f32_32x32x16_bf16 v[100:115], v[148:151], v[188:191], v[100:115]
sk_31:
    s_waitcnt lgkmcnt(14)
    ds_read_b64_tr_b16 v[172:173], v5 offset:8192
    s_waitcnt lgkmcnt(14)
    ds_read_b64_tr_b16 v[174:175], v5 offset:10240
    s_waitcnt lgkmcnt(9)
    v_mfma_f32_32x32x16_bf16 v[52:67], v[152:155], v[192:195], v[52:67]
    s_lshl_b32 s82, s2, 13
    s_cmp_eq_u32 s5, 3
    s_cselect_b32 s83, 0, 0x7ffffff0
    v_lshlrev_b32 v224, 7, v1
    v_add_u32 v224, s82, v224
    buffer_load_dword v225, v224, s[24:27], s83 offen
    v_subrev_u32 v224, 1605632, v224
    buffer_load_dword v226, v224, s[28:31], s83 offen
    ds_read_b64_tr_b16 v[176:177], v10 offset:16384
    ds_read_b64_tr_b16 v[178:179], v10 offset:18432
    ds_read_b128 v[148:151], v8 offset:32768
    v_mfma_f32_32x32x16_bf16 v[68:83], v[152:155], v[196:199], v[68:83]
    s_lshl_b32 s82, s3, 2
    s_add_u32 s82, s82, s6
    s_lshl_b32 s82, s82, 4
    s_add_u32 s82, s82, s4
    s_lshl_b32 s82, s82, 5
    s_add_u32 s82, s82, 262144
    s_cmp_eq_u32 s7, 0
    s_cselect_b32 s82, s82, 0x7ffffff0
    v_min_u32 v228, 2, v1
    v_lshlrev_b32 v228, 17, v228
    buffer_load_dword v229, v228, s[36:39], s82 offen sc1
    ds_read_b64_tr_b16 v[180:181], v11 offset:16384
    ds_read_b64_tr_b16 v[182:183], v11 offset:18432
    v_mfma_f32_32x32x16_bf16 v[84:99], v[152:155], v[200:203], v[84:99]
    s_cmp_ge_u32 s5, 4
    s_cbranch_scc1 csi_29
    v_lshlrev_b32 v2, 3, v0
    s_lshl_b32 s96, s4, 16
    s_add_u32 s96, s96, 19922944
    s_add_u32 s97, s96, 4096
    s_add_u32 s98, s96, 8192
    s_add_u32 s99, s96, 12288
    buffer_load_dwordx2 v[130:131], v2, s[36:39], s96 offen offset:0 sc1
    buffer_load_dwordx2 v[132:133], v2, s[36:39], s96 offen offset:2048 sc1
    buffer_load_dwordx2 v[134:135], v2, s[36:39], s97 offen offset:0 sc1
    buffer_load_dwordx2 v[136:137], v2, s[36:39], s97 offen offset:2048 sc1
    buffer_load_dwordx2 v[138:139], v2, s[36:39], s98 offen offset:0 sc1
    buffer_load_dwordx2 v[140:141], v2, s[36:39], s98 offen offset:2048 sc1
    buffer_load_dwordx2 v[142:143], v2, s[36:39], s99 offen offset:0 sc1
csi_29:
    ds_read_b64_tr_b16 v[184:185], v12 offset:16384
    s_waitcnt lgkmcnt(14)
    ds_read_b64_tr_b16 v[186:187], v12 offset:18432
    s_cmp_eq_u32 s7, 1
    s_cbranch_scc1 sk_32
    v_mfma_f32_32x32x16_bf16 v[100:115], v[152:155], v[204:207], v[100:115]
sk_32:
    s_waitcnt lgkmcnt(14)
    ds_read_b64_tr_b16 v[188:189], v5 offset:16384
    s_waitcnt lgkmcnt(14)
    ds_read_b64_tr_b16 v[190:191], v5 offset:18432
    s_waitcnt lgkmcnt(9)
    v_mfma_f32_32x32x16_bf16 v[52:67], v[144:147], v[160:163], v[52:67]
    s_lshl_b32 s68, s3, 2
    s_add_u32 s68, s68, s6
    s_lshl_b32 s68, s68, 9
    s_add_u32 s68, s68, 131072
    v_and_b32 v128, 31, v1
    v_lshlrev_b32 v128, 4, v128
    ds_read_b64_tr_b16 v[192:193], v10 offset:24576
    ds_read_b64_tr_b16 v[194:195], v10 offset:26624
    ds_read_b128 v[152:155], v9 offset:32768
    ds_read_b64_tr_b16 v[196:197], v11 offset:24576
    ds_read_b64_tr_b16 v[198:199], v11 offset:26624
    ds_read_b64_tr_b16 v[200:201], v12 offset:24576
    s_waitcnt lgkmcnt(14)
    ds_read_b64_tr_b16 v[202:203], v12 offset:26624
    s_waitcnt lgkmcnt(14)
    ds_read_b64_tr_b16 v[204:205], v5 offset:24576
    s_waitcnt lgkmcnt(14)
    ds_read_b64_tr_b16 v[206:207], v5 offset:26624
    v_mfma_f32_32x32x16_bf16 v[68:83], v[144:147], v[164:167], v[68:83]
    buffer_load_dwordx4 v[124:127], v128, s[36:39], s68 offen sc1
    v_add_u32 v10, 0xffff0000, v10
    v_add_u32 v11, 0xffff0000, v11
    v_add_u32 v12, 0xffff0000, v12
    v_add_u32 v5, 0xffff0000, v5
    v_mfma_f32_32x32x16_bf16 v[84:99], v[144:147], v[168:171], v[84:99]
    s_cmp_eq_u32 s7, 1
    s_cbranch_scc1 sk_33
    v_mfma_f32_32x32x16_bf16 v[100:115], v[144:147], v[172:175], v[100:115]
sk_33:
    s_waitcnt vmcnt(5)
    s_waitcnt lgkmcnt(0)
    s_barrier
    v_mfma_f32_32x32x16_bf16 v[52:67], v[148:151], v[176:179], v[52:67]
    ds_read_b64_tr_b16 v[160:161], v10 offset:0
    ds_read_b64_tr_b16 v[162:163], v10 offset:2048
    ds_read_b128 v[144:147], v6 offset:0
    v_mfma_f32_32x32x16_bf16 v[68:83], v[148:151], v[180:183], v[68:83]
    ds_read_b64_tr_b16 v[164:165], v11 offset:0
    ds_read_b64_tr_b16 v[166:167], v11 offset:2048
    v_mfma_f32_32x32x16_bf16 v[84:99], v[148:151], v[184:187], v[84:99]
    ds_read_b64_tr_b16 v[168:169], v12 offset:0
    ds_read_b64_tr_b16 v[170:171], v12 offset:2048
    s_cmp_eq_u32 s7, 1
    s_cbranch_scc1 sk_37
    v_mfma_f32_32x32x16_bf16 v[100:115], v[148:151], v[188:191], v[100:115]
sk_37:
    ds_read_b64_tr_b16 v[172:173], v5 offset:0
    ds_read_b64_tr_b16 v[174:175], v5 offset:2048
    v_mfma_f32_32x32x16_bf16 v[52:67], v[152:155], v[192:195], v[52:67]
    ds_read_b64_tr_b16 v[176:177], v10 offset:8192
    ds_read_b64_tr_b16 v[178:179], v10 offset:10240
    ds_read_b128 v[148:151], v7 offset:0
    v_mfma_f32_32x32x16_bf16 v[68:83], v[152:155], v[196:199], v[68:83]
    ds_read_b64_tr_b16 v[180:181], v11 offset:8192
    ds_read_b64_tr_b16 v[182:183], v11 offset:10240
    v_mfma_f32_32x32x16_bf16 v[84:99], v[152:155], v[200:203], v[84:99]
    ds_read_b64_tr_b16 v[184:185], v12 offset:8192
    s_waitcnt lgkmcnt(14)
    ds_read_b64_tr_b16 v[186:187], v12 offset:10240
    s_cmp_eq_u32 s7, 1
    s_cbranch_scc1 sk_38
    v_mfma_f32_32x32x16_bf16 v[100:115], v[152:155], v[204:207], v[100:115]
sk_38:
    s_waitcnt lgkmcnt(14)
    ds_read_b64_tr_b16 v[188:189], v5 offset:8192
    s_waitcnt lgkmcnt(14)
    ds_read_b64_tr_b16 v[190:191], v5 offset:10240
    s_waitcnt lgkmcnt(9)
    v_mfma_f32_32x32x16_bf16 v[52:67], v[144:147], v[160:163], v[52:67]
    s_cmp_ge_u32 s5, 4
    s_waitcnt vmcnt(1)
    s_cbranch_scc1 csf_34
    v_xor_b32 v17, s64, v131
    v_mov_b32 v18, s64
    v_bitop3_b32 v17, v133, v18, v17 bitop3:0xbe
    v_bitop3_b32 v17, v135, v18, v17 bitop3:0xbe
    v_bitop3_b32 v17, v137, v18, v17 bitop3:0xbe
    v_bitop3_b32 v17, v139, v18, v17 bitop3:0xbe
    v_bitop3_b32 v17, v141, v18, v17 bitop3:0xbe
    v_bitop3_b32 v17, v143, v18, v17 bitop3:0xbe
    v_cmp_ne_u32 vcc, 0, v17
    s_cbranch_vccnz chk_35_slow
chk_35_back:
    v_add_f32 v130, v130, v132
    v_add_f32 v134, v134, v136
    v_add_f32 v138, v138, v140
    v_add_f32 v130, v130, v142
    v_add_f32 v134, v134, v138
    v_lshrrev_b32 v17, 1, v2
    v_add_u32 v17, 155648, v17
    v_add_f32 v130, v130, v134
    ds_write_b32 v17, v130
csf_34:
    s_waitcnt vmcnt(0)
    v_cmp_ne_u32 vcc, s64, v127
    s_cbranch_vccnz chk_36_slow
chk_36_back:
    s_lshl_b32 s68, s3, 2
    s_add_u32 s68, s68, s6
    s_lshl_b32 s68, s68, 4
    s_add_u32 s68, s68, s4
    s_lshl_b32 s68, s68, 3
    s_add_u32 s68, s68, s7
    s_lshl_b32 s68, s68, 2
    v_cmp_gt_u32 vcc, 32, v1
    v_sub_f32 v128, 0, v125
    v_mov_b32 v18, 0
    v_cndmask_b32 v128, 0, v128, vcc
    v_cvt_pk_bf16_f32 v16, v128, v128
    ds_read_b64_tr_b16 v[192:193], v10 offset:16384
    ds_read_b64_tr_b16 v[194:195], v10 offset:18432
    ds_read_b128 v[152:155], v8 offset:0
    v_mfma_f32_32x32x16_bf16 v[68:83], v[144:147], v[164:167], v[68:83]
    v_mov_b32 v19, 0
    v_and_b32 v17, 0xffff0000, v16
    v_sub_f32 v128, v128, v17
    v_cvt_pk_bf16_f32 v17, v128, 0
    v_and_b32 v128, 31, v1
    ds_read_b64_tr_b16 v[196:197], v11 offset:16384
    ds_read_b64_tr_b16 v[198:199], v11 offset:18432
    v_mfma_f32_32x32x16_bf16 v[84:99], v[144:147], v[168:171], v[84:99]
    s_lshl_b32 s90, s5, 8
    s_add_u32 s90, s90, 157696
    v_lshlrev_b32 v129, 2, v128
    v_add_u32 v130, s90, v129
    ds_write_b32 v130, v124
    s_waitcnt lgkmcnt(14)
    ds_read_b64_tr_b16 v[200:201], v12 offset:16384
    s_waitcnt lgkmcnt(14)
    ds_read_b64_tr_b16 v[202:203], v12 offset:18432
    s_cmp_eq_u32 s7, 1
    s_cbranch_scc1 sk_39
    v_mfma_f32_32x32x16_bf16 v[100:115], v[144:147], v[172:175], v[100:115]
sk_39:
    s_waitcnt lgkmcnt(14)
    ds_read_b64_tr_b16 v[204:205], v5 offset:16384
    s_waitcnt lgkmcnt(14)
    ds_read_b64_tr_b16 v[206:207], v5 offset:18432
    s_waitcnt lgkmcnt(10)
    v_mfma_f32_32x32x16_bf16 v[52:67], v[148:151], v[176:179], v[52:67]
    v_lshrrev_b32 v127, 5, v1
    v_lshlrev_b32 v130, 4, v127
    v_add_u32 v130, s90, v130
    s_lshl_b32 s90, s7, 9
    s_add_u32 s90, s90, 155648
    ds_read_b64_tr_b16 v[160:161], v10 offset:24576
    ds_read_b64_tr_b16 v[162:163], v10 offset:26624
    ds_read_b128 v[144:147], v9 offset:0
    ds_read_b64_tr_b16 v[164:165], v11 offset:24576
    ds_read_b64_tr_b16 v[166:167], v11 offset:26624
    s_waitcnt lgkmcnt(14)
    ds_read_b64_tr_b16 v[168:169], v12 offset:24576
    s_waitcnt lgkmcnt(14)
    ds_read_b64_tr_b16 v[170:171], v12 offset:26624
    s_waitcnt lgkmcnt(14)
    ds_read_b64_tr_b16 v[172:173], v5 offset:24576
    s_waitcnt lgkmcnt(14)
    ds_read_b64_tr_b16 v[174:175], v5 offset:26624
    v_mfma_f32_32x32x16_bf16 v[68:83], v[148:151], v[180:183], v[68:83]
    v_add_u32 v126, s90, v129
    v_mov_b32 v118, 0
    v_mov_b32 v119, 0
    v_mov_b32 v122, 0
    v_mov_b32 v123, 0
    v_mfma_f32_32x32x16_bf16 v[84:99], v[148:151], v[184:187], v[84:99]
    s_waitcnt lgkmcnt(14)
    ds_read_b128 v[20:23], v130 offset:0
    s_waitcnt lgkmcnt(14)
    ds_read_b128 v[24:27], v130 offset:32
    s_waitcnt lgkmcnt(14)
    ds_read_b128 v[28:31], v130 offset:64
    s_waitcnt lgkmcnt(14)
    ds_read_b128 v[32:35], v130 offset:96
    s_cmp_eq_u32 s7, 1
    s_cbranch_scc1 sk_40
    v_mfma_f32_32x32x16_bf16 v[100:115], v[148:151], v[188:191], v[100:115]
sk_40:
    s_waitcnt lgkmcnt(13)
    v_mfma_f32_32x32x16_bf16 v[52:67], v[152:155], v[192:195], v[52:67]
    v_mfma_f32_32x32x16_bf16 v[68:83], v[152:155], v[196:199], v[68:83]
    v_mfma_f32_32x32x16_bf16 v[84:99], v[152:155], v[200:203], v[84:99]
    s_cmp_eq_u32 s7, 1
    s_cbranch_scc1 sk_41
    v_mfma_f32_32x32x16_bf16 v[100:115], v[152:155], v[204:207], v[100:115]
sk_41:
    s_waitcnt lgkmcnt(4)
    v_mfma_f32_32x32x16_bf16 v[52:67], v[144:147], v[160:163], v[52:67]
    v_mfma_f32_32x32x16_bf16 v[68:83], v[144:147], v[164:167], v[68:83]
    v_mfma_f32_32x32x16_bf16 v[84:99], v[144:147], v[168:171], v[84:99]
    s_cmp_eq_u32 s7, 1
    s_cbranch_scc1 sk_42
    v_mfma_f32_32x32x16_bf16 v[100:115], v[144:147], v[172:175], v[100:115]
sk_42:
    s_waitcnt lgkmcnt(0)
    s_barrier
    ds_read_b32 v140, v126 offset:0
    ds_read_b32 v141, v126 offset:128
    ds_read_b32 v142, v126 offset:256
    ds_read_b32 v143, v126 offset:384
    s_waitcnt lgkmcnt(3)
    v_cvt_pk_bf16_f32 v117, v140, 0
    v_lshlrev_b32 v116, 16, v117
    v_sub_f32 v116, v140, v116
    v_cvt_pk_bf16_f32 v116, v140, v116
    s_nop 1
    v_mfma_f32_32x32x16_bf16 v[52:67], v[16:19], v[116:119], v[52:67]
    s_waitcnt lgkmcnt(2)
    v_cvt_pk_bf16_f32 v121, v141, 0
    v_lshlrev_b32 v120, 16, v121
    v_sub_f32 v120, v141, v120
    v_cvt_pk_bf16_f32 v120, v141, v120
    s_nop 1
    v_mfma_f32_32x32x16_bf16 v[68:83], v[16:19], v[120:123], v[68:83]
    s_waitcnt lgkmcnt(1)
    v_cvt_pk_bf16_f32 v117, v142, 0
    v_lshlrev_b32 v116, 16, v117
    v_sub_f32 v116, v142, v116
    v_cvt_pk_bf16_f32 v116, v142, v116
    s_nop 1
    v_mfma_f32_32x32x16_bf16 v[84:99], v[16:19], v[116:119], v[84:99]
    s_waitcnt lgkmcnt(0)
    v_cvt_pk_bf16_f32 v121, v143, 0
    v_lshlrev_b32 v120, 16, v121
    v_sub_f32 v120, v143, v120
    v_cvt_pk_bf16_f32 v120, v143, v120
    s_nop 1
    v_mfma_f32_32x32x16_bf16 v[100:115], v[16:19], v[120:123], v[100:115]
    v_mul_f32 v52, v20, v52
    v_mul_f32 v53, v21, v53
    v_mul_f32 v54, v22, v54
    v_mul_f32 v55, v23, v55
    v_mul_f32 v56, v24, v56
    v_mul_f32 v57, v25, v57
    v_mul_f32 v58, v26, v58
    v_mul_f32 v59, v27, v59
    v_mul_f32 v60, v28, v60
    v_mul_f32 v61, v29, v61
    v_mul_f32 v62, v30, v62
    v_mul_f32 v63, v31, v63
    v_mul_f32 v64, v32, v64
    v_mul_f32 v65, v33, v65
    v_mul_f32 v66, v34, v66
    v_mul_f32 v67, v35, v67
    v_cvt_pk_bf16_f32 v224, v52, v53
    v_cvt_pk_bf16_f32 v225, v54, v55
    v_cvt_pk_bf16_f32 v226, v60, v61
    v_cvt_pk_bf16_f32 v227, v62, v63
    buffer_store_dwordx4 v[224:227], v208, s[36:39], s42 offen offset:0 sc1
    v_cvt_pk_bf16_f32 v228, v56, v57
    v_cvt_pk_bf16_f32 v229, v58, v59
    v_cvt_pk_bf16_f32 v230, v64, v65
    v_cvt_pk_bf16_f32 v231, v66, v67
    buffer_store_dwordx4 v[228:231], v208, s[36:39], s42 offen offset:512 sc1
    v_mul_f32 v68, v20, v68
    v_mul_f32 v69, v21, v69
    v_mul_f32 v70, v22, v70
    v_mul_f32 v71, v23, v71
    v_mul_f32 v72, v24, v72
    v_mul_f32 v73, v25, v73
    v_mul_f32 v74, v26, v74
    v_mul_f32 v75, v27, v75
    v_mul_f32 v76, v28, v76
    v_mul_f32 v77, v29, v77
    v_mul_f32 v78, v30, v78
    v_mul_f32 v79, v31, v79
    v_mul_f32 v80, v32, v80
    v_mul_f32 v81, v33, v81
    v_mul_f32 v82, v34, v82
    v_mul_f32 v83, v35, v83
    v_cvt_pk_bf16_f32 v232, v68, v69
    v_cvt_pk_bf16_f32 v233, v70, v71
    v_cvt_pk_bf16_f32 v234, v76, v77
    v_cvt_pk_bf16_f32 v235, v78, v79
    buffer_store_dwordx4 v[232:235], v209, s[36:39], s42 offen offset:0 sc1
    v_cvt_pk_bf16_f32 v236, v72, v73
    v_cvt_pk_bf16_f32 v237, v74, v75
    v_cvt_pk_bf16_f32 v238, v80, v81
    v_cvt_pk_bf16_f32 v239, v82, v83
    buffer_store_dwordx4 v[236:239], v209, s[36:39], s42 offen offset:512 sc1
    v_mul_f32 v84, v20, v84
    v_mul_f32 v85, v21, v85
    v_mul_f32 v86, v22, v86
    v_mul_f32 v87, v23, v87
    v_mul_f32 v88, v24, v88
    v_mul_f32 v89, v25, v89
    v_mul_f32 v90, v26, v90
    v_mul_f32 v91, v27, v91
    v_mul_f32 v92, v28, v92
    v_mul_f32 v93, v29, v93
    v_mul_f32 v94, v30, v94
    v_mul_f32 v95, v31, v95
    v_mul_f32 v96, v32, v96
    v_mul_f32 v97, v33, v97
    v_mul_f32 v98, v34, v98
    v_mul_f32 v99, v35, v99
    v_cvt_pk_bf16_f32 v240, v84, v85
    v_cvt_pk_bf16_f32 v241, v86, v87
    v_cvt_pk_bf16_f32 v242, v92, v93
    v_cvt_pk_bf16_f32 v243, v94, v95
    buffer_store_dwordx4 v[240:243], v210, s[36:39], s42 offen offset:0 sc1
    v_cvt_pk_bf16_f32 v244, v88, v89
    v_cvt_pk_bf16_f32 v245, v90, v91
    v_cvt_pk_bf16_f32 v246, v96, v97
    v_cvt_pk_bf16_f32 v247, v98, v99
    buffer_store_dwordx4 v[244:247], v210, s[36:39], s42 offen offset:512 sc1
    v_mul_f32 v100, v20, v100
    v_mul_f32 v101, v21, v101
    v_mul_f32 v102, v22, v102
    v_mul_f32 v103, v23, v103
    v_mul_f32 v104, v24, v104
    v_mul_f32 v105, v25, v105
    v_mul_f32 v106, v26, v106
    v_mul_f32 v107, v27, v107
    v_mul_f32 v108, v28, v108
    v_mul_f32 v109, v29, v109
    v_mul_f32 v110, v30, v110
    v_mul_f32 v111, v31, v111
    v_mul_f32 v112, v32, v112
    v_mul_f32 v113, v33, v113
    v_mul_f32 v114, v34, v114
    v_mul_f32 v115, v35, v115
    v_cvt_pk_bf16_f32 v248, v100, v101
    v_cvt_pk_bf16_f32 v249, v102, v103
    v_cvt_pk_bf16_f32 v250, v108, v109
    v_cvt_pk_bf16_f32 v251, v110, v111
    buffer_store_dwordx4 v[248:251], v211, s[36:39], s42 offen offset:0 sc1
    v_cvt_pk_bf16_f32 v252, v104, v105
    v_cvt_pk_bf16_f32 v253, v106, v107
    v_cvt_pk_bf16_f32 v254, v112, v113
    v_cvt_pk_bf16_f32 v255, v114, v115
    buffer_store_dwordx4 v[252:255], v211, s[36:39], s42 offen offset:512 sc1
    v_mov_b32 v6, s64
    s_add_u32 s82, s68, 262144
    s_waitcnt vmcnt(0)
    s_mov_b64 exec, 1
    buffer_store_dword v6, off, s[36:39], s82 sc1
    s_mov_b64 exec, -1
    s_lshr_b32 s82, s2, 3
    s_and_b32 s83, s2, 7
    s_cmp_lt_u32 s82, 28
    s_cselect_b32 s80, 1, 0
    s_min_u32 s82, s82, 27
    s_mul_i32 s84, s82, 37
    s_lshr_b32 s84, s84, 8
    s_mul_i32 s85, s84, 7
    s_sub_u32 s78, s82, s85
    s_lshl_b32 s83, s83, 2
    s_add_u32 s77, s83, s84
    s_lshl_b32 s84, s84, 1
    s_add_u32 s79, s78, s84
    s_sub_u32 s84, s79, 7
    s_cmp_ge_u32 s79, 7
    s_cselect_b32 s79, s84, s79
    s_mul_i32 s56, s79, 229376
    s_add_u32 s57, s56, 229376
    s_cmp_eq_u32 s57, 1605632
    s_cselect_b32 s57, 0, s57
    s_add_u32 s58, s57, 229376
    s_cmp_eq_u32 s58, 1605632
    s_cselect_b32 s58, 0, s58
    s_add_u32 s59, s58, 229376
    s_cmp_eq_u32 s59, 1605632
    s_cselect_b32 s59, 0, s59
    s_add_u32 s60, s59, 229376
    s_cmp_eq_u32 s60, 1605632
    s_cselect_b32 s60, 0, s60
    s_add_u32 s61, s60, 229376
    s_cmp_eq_u32 s61, 1605632
    s_cselect_b32 s61, 0, s61
    s_add_u32 s62, s61, 229376
    s_cmp_eq_u32 s62, 1605632
    s_cselect_b32 s62, 0, s62
    s_lshl_b32 s82, s77, 1
    s_add_u32 s82, s82, s7
    s_mul_i32 s43, s82, 32768
    s_lshl_b32 s83, s6, 10
    s_add_u32 s43, s43, s83
    s_add_u32 s43, s43, 16777216
    s_cmp_ge_u32 s82, 56
    s_cselect_b32 s63, 1376256, 0
    s_lshl_b32 s82, s82, 12
    s_add_u32 s63, s63, s82
    s_add_u32 s63, s63, 22020096
    s_bitcmp1_b32 s6, 0
    s_cselect_b32 s83, 3211264, 0
    s_add_u32 s63, s63, s83
    s_lshr_b32 s83, s6, 1
    s_lshl_b32 s83, s83, 11
    s_add_u32 s63, s63, s83
    s_cmp_eq_u32 s80, 0
    s_cselect_b32 s82, 0x4000000, 0
    s_add_u32 s63, s63, s82
    s_mul_i32 s101, s5, 3072
    s_lshr_b32 s82, s4, 1
    s_mul_i32 s82, s82, 1792
    s_bitcmp1_b32 s4, 0
    s_cselect_b32 s83, 768, 0
    s_add_u32 s82, s82, s83
    s_lshl_b32 s41, s4, 10
    s_sub_u32 s41, s41, s82
    s_add_u32 s41, s41, 2097152
    s_lshl_b32 s83, s3, 3
    s_add_u32 s42, s83, s5
    s_lshl_b32 s42, s42, 14
    s_add_u32 s42, s42, s82
    s_add_u32 s42, s42, 1048576
    s_add_u32 s69, s82, 3145728
    s_mul_i32 s82, s5, 3
    s_lshl_b32 s83, s3, 3
    s_add_u32 s83, s83, s82
    s_sub_i32 s83, s83, 16
    s_and_b32 s84, s83, 1
    s_max_i32 s83, s83, s84
    s_lshl_b32 s83, s83, 14
    s_add_u32 s0, s69, s83
    s_mul_i32 s82, s5, 3
    s_lshl_b32 s83, s3, 3
    s_add_u32 s83, s83, s82
    s_sub_i32 s83, s83, 15
    s_and_b32 s84, s83, 1
    s_max_i32 s83, s83, s84
    s_lshl_b32 s83, s83, 14
    s_add_u32 s1, s69, s83
    s_mul_i32 s82, s5, 3
    s_lshl_b32 s83, s3, 3
    s_add_u32 s83, s83, s82
    s_sub_i32 s83, s83, 14
    s_and_b32 s84, s83, 1
    s_max_i32 s83, s83, s84
    s_lshl_b32 s83, s83, 14
    s_add_u32 s69, s69, s83
    v_lshrrev_b32 v6, 3, v1
    s_lshl_b32 s82, s5, 3
    v_add_u32 v6, s82, v6
    v_lshrrev_b32 v7, 2, v1
    v_and_b32 v7, 4, v7
    v_and_b32 v8, 7, v1
    v_xor_b32 v7, v7, v8
    v_lshlrev_b32 v7, 4, v7
    s_movk_i32 s83, 896
    v_mad_u32_u24 v3, v6, s83, v7
    s_lshl_b32 s84, s78, 7
    v_add_u32 v3, s84, v3
    s_lshl_b32 s82, s77, 1
    s_add_u32 s82, s82, s7
    s_lshl_b32 s84, s82, 9
    s_add_u32 s84, s84, 393216
    v_bfe_u32 v150, v1, 1, 3
    v_min_u32 v150, 6, v150
    v_add_u32 v150, s79, v150
    v_subrev_u32 v151, 7, v150
    v_min_u32 v150, v150, v151
    v_and_b32 v151, 1, v1
    v_lshl_add_u32 v150, v150, 1, v151
    v_lshlrev_b32 v150, 5, v150
    v_add_u32 v150, s84, v150
    v_add_u32 v151, 131072, v150
    v_lshlrev_b32 v75, 4, v1
    v_mov_b32 v72, 0xf149f2ca
    s_and_b32 s82, s5, 6
    s_lshl_b32 s82, s82, 10
    v_add_u32 v148, s82, v75
    s_bitcmp1_b32 s5, 0
    s_cselect_b64 s[20:21], -1, 0
    v_add_u32 v149, 24576, v148
    v_lshrrev_b32 v64, 4, v1
    v_and_b32 v65, 15, v1
    v_lshlrev_b32 v66, 2, v64
    v_sub_u32 v66, v66, v65
    v_lshrrev_b32 v67, 2, v65
    v_lshlrev_b32 v57, 1, v67
    v_add_u32 v57, 12, v57
    v_sub_u32 v57, v57, v65
    v_and_b32 v56, 3, v1
    v_cmp_eq_u32 vcc, 3, v56
    s_nop 1
    v_cndmask_b32 v57, 0, v57, vcc
    v_sub_u32 v57, v57, v67
    v_lshl_add_u32 v57, v57, 4, v149
    v_cmp_ge_i32 s[12:13], 0, v66
    v_cmp_ge_i32 s[14:15], -1, v66
    v_cmp_ge_i32 s[16:17], -2, v66
    v_cmp_ge_i32 s[18:19], -3, v66
    v_lshlrev_b32 v65, 4, v65
    v_lshl_add_u32 v56, v64, 9, v65
    s_lshl_b32 s82, s3, 2
    s_lshr_b32 s83, s5, 1
    s_add_u32 s82, s82, s83
    s_mul_i32 s82, s82, 32768
    s_and_b32 s83, s5, 1
    s_lshl_b32 s83, s83, 8
    s_add_u32 s82, s82, s83
    s_add_u32 s82, s82, 16777216
    s_lshl_b32 s83, s4, 11
    s_add_u32 s75, s82, s83
    s_and_b32 s76, s64, 0xffff0000
    v_bfe_u32 v64, v1, 2, 2
    v_lshrrev_b32 v65, 5, v1
    v_lshl_add_u32 v66, v65, 2, v64
    v_lshlrev_b32 v66, 7, v66
    v_and_b32 v67, 3, v1
    v_lshlrev_b32 v67, 3, v67
    v_bfe_u32 v55, v1, 4, 1
    v_lshl_add_u32 v67, v55, 5, v67
    v_add_u32 v66, v66, v67
    v_bfe_u32 v55, v1, 3, 1
    v_lshl_add_u32 v66, v55, 6, v66
    s_lshl_b32 s82, s6, 11
    s_add_u32 s82, s82, 49152
    v_add_u32 v44, s82, v66
    v_xor_b32 v45, 64, v44
    v_mov_b32 v46, v66
    v_mov_b32 v50, v67
    s_mul_i32 s82, s5, 3
    s_lshl_b32 s83, s3, 3
    s_add_u32 s82, s82, s83
    s_sub_i32 s82, s82, 16
    s_ashr_i32 s82, s82, 1
    s_lshl_b32 s83, s3, 2
    s_lshr_b32 s84, s5, 1
    s_add_u32 s83, s83, s84
    s_lshr_b32 s84, s4, 1
    s_mul_i32 s84, s84, 7
    s_bitcmp1_b32 s4, 0
    s_cselect_b32 s85, 3, 0
    s_add_u32 s84, s84, s85
    s_add_u32 s85, s84, 3
    s_lshr_b32 s84, s84, 3
    s_lshr_b32 s85, s85, 3
    s_sub_u32 s85, s85, s84
    s_lshr_b32 s86, s4, 3
    s_lshl_b32 s86, s86, 5
    s_add_u32 s86, s86, 262592
    v_bfe_u32 v6, v1, 2, 1
    v_add_u32 v6, s82, v6
    v_max_i32 v6, 0, v6
    v_mov_b32 v7, s83
    v_and_b32 v8, 8, v1
    v_cmp_ne_u32 vcc, 0, v8
    v_and_b32 v8, 1, v1
    v_mul_u32_u24 v8, s85, v8
    v_add_u32 v8, s84, v8
    v_lshlrev_b32 v61, 9, v6
    v_cndmask_b32 v6, v6, v7, vcc
    v_add_u32 v7, 7, v8
    v_add_u32 v61, s86, v61
    v_cndmask_b32 v8, v7, v8, vcc
    v_lshlrev_b32 v6, 9, v6
    v_lshl_add_u32 v6, v8, 5, v6
    v_add_u32 v60, 262144, v6
    s_lshr_b32 s82, s2, 3
    s_lshl_b32 s82, s82, 15
    s_add_u32 s82, s82, 0
    s_cmp_eq_u32 s7, 0
    s_cselect_b32 s83, 0, 0x7ffffff0
    v_and_b32 v6, 0xff, v0
    v_lshlrev_b32 v6, 7, v6
    v_add_u32 v6, s82, v6
    buffer_load_dword v144, v6, s[24:27], s83 offen
    s_lshr_b32 s82, s2, 3
    s_lshl_b32 s82, s82, 15
    s_add_u32 s82, s82, 1048576
    s_cmp_eq_u32 s7, 1
    s_cselect_b32 s83, 0, 0x7ffffff0
    v_and_b32 v6, 0xff, v0
    v_lshlrev_b32 v6, 7, v6
    v_add_u32 v6, s82, v6
    buffer_load_dword v146, v6, s[24:27], s83 offen
    v_subrev_u32 v6, 1605632, v6
    buffer_load_dword v147, v6, s[28:31], s83 offen
    buffer_load_dwordx2 v[62:63], v60, s[36:39], 0 offen sc1
    s_waitcnt vmcnt(0)
    v_xor_b32 v6, s64, v62
    v_mov_b32 v7, s64
    v_bitop3_b32 v6, v63, v7, v6 bitop3:0xbe
    v_cmp_ne_u32 vcc, 0, v6
    s_cbranch_vccnz chk_43_slow
chk_43_back:
    s_add_u32 m0, s101, 0
    s_nop 0
    buffer_load_dwordx4 v75, s[36:39], s0 offen sc1 lds
    s_add_u32 m0, s101, 1024
    s_nop 0
    buffer_load_dwordx4 v75, s[36:39], s1 offen sc1 lds
    s_add_u32 m0, s101, 2048
    s_nop 0
    buffer_load_dwordx4 v75, s[36:39], s69 offen sc1 lds
    buffer_load_dwordx4 v[68:71], v75, s[36:39], s42 offen sc1
    s_add_u32 m0, s66, 49152
    s_add_u32 s82, s56, 0
    buffer_load_dwordx4 v3, s[24:27], s82 offen lds
    s_add_u32 m0, s66, 57344
    s_add_u32 s82, s56, 114688
    buffer_load_dwordx4 v3, s[24:27], s82 offen lds
    s_add_u32 m0, s66, 65536
    s_add_u32 s82, s57, 0
    buffer_load_dwordx4 v3, s[24:27], s82 offen lds
    s_add_u32 m0, s66, 73728
    s_add_u32 s82, s57, 114688
    buffer_load_dwordx4 v3, s[24:27], s82 offen lds
    s_add_u32 m0, s66, 81920
    s_add_u32 s82, s58, 0
    buffer_load_dwordx4 v3, s[24:27], s82 offen lds
    s_add_u32 m0, s66, 90112
    s_add_u32 s82, s58, 114688
    buffer_load_dwordx4 v3, s[24:27], s82 offen lds
    s_waitcnt vmcnt(6)
    s_barrier
    s_nop 11
    s_branch L_att
chk_4_slow:
    s_add_u32 s100, s100, 1
    s_cmp_gt_u32 s100, 200000
    s_cbranch_scc1 chk_4_back
    s_nop 4
    s_sleep 4
    buffer_load_dwordx2 v[130:131], v2, s[36:39], s96 offen offset:0 sc1
    buffer_load_dwordx2 v[132:133], v2, s[36:39], s96 offen offset:2048 sc1
    buffer_load_dwordx2 v[134:135], v2, s[36:39], s97 offen offset:0 sc1
    buffer_load_dwordx2 v[136:137], v2, s[36:39], s97 offen offset:2048 sc1
    buffer_load_dwordx2 v[138:139], v2, s[36:39], s98 offen offset:0 sc1
    buffer_load_dwordx2 v[140:141], v2, s[36:39], s98 offen offset:2048 sc1
    buffer_load_dwordx2 v[142:143], v2, s[36:39], s99 offen offset:0 sc1
    s_waitcnt vmcnt(0)
    v_xor_b32 v17, s64, v131
    v_mov_b32 v18, s64
    v_bitop3_b32 v17, v133, v18, v17 bitop3:0xbe
    v_bitop3_b32 v17, v135, v18, v17 bitop3:0xbe
    v_bitop3_b32 v17, v137, v18, v17 bitop3:0xbe
    v_bitop3_b32 v17, v139, v18, v17 bitop3:0xbe
    v_bitop3_b32 v17, v141, v18, v17 bitop3:0xbe
    v_bitop3_b32 v17, v143, v18, v17 bitop3:0xbe
    v_cmp_ne_u32 vcc, 0, v17
    s_cbranch_vccnz chk_4_slow
    s_nop 4
    s_branch chk_4_back
chk_5_slow:
    s_add_u32 s100, s100, 1
    s_cmp_gt_u32 s100, 200000
    s_cbranch_scc1 chk_5_back
    s_nop 4
    s_sleep 4
    buffer_load_dwordx4 v[124:127], v128, s[36:39], s68 offen sc1
    s_waitcnt vmcnt(0)
    v_cmp_ne_u32 vcc, s64, v127
    s_cbranch_vccnz chk_5_slow
    s_nop 4
    s_branch chk_5_back
chk_8_slow:
    s_add_u32 s100, s100, 1
    s_cmp_gt_u32 s100, 200000
    s_cbranch_scc1 chk_8_back
    s_nop 4
    s_sleep 4
    buffer_load_dwordx2 v[130:131], v2, s[36:39], s96 offen offset:0 sc1
    buffer_load_dwordx2 v[132:133], v2, s[36:39], s96 offen offset:2048 sc1
    buffer_load_dwordx2 v[134:135], v2, s[36:39], s97 offen offset:0 sc1
    buffer_load_dwordx2 v[136:137], v2, s[36:39], s97 offen offset:2048 sc1
    buffer_load_dwordx2 v[138:139], v2, s[36:39], s98 offen offset:0 sc1
    buffer_load_dwordx2 v[140:141], v2, s[36:39], s98 offen offset:2048 sc1
    buffer_load_dwordx2 v[142:143], v2, s[36:39], s99 offen offset:0 sc1
    s_waitcnt vmcnt(0)
    v_xor_b32 v6, s64, v131
    v_mov_b32 v7, s64
    v_bitop3_b32 v6, v133, v7, v6 bitop3:0xbe
    v_bitop3_b32 v6, v135, v7, v6 bitop3:0xbe
    v_bitop3_b32 v6, v137, v7, v6 bitop3:0xbe
    v_bitop3_b32 v6, v139, v7, v6 bitop3:0xbe
    v_bitop3_b32 v6, v141, v7, v6 bitop3:0xbe
    v_bitop3_b32 v6, v143, v7, v6 bitop3:0xbe
    v_cmp_ne_u32 vcc, 0, v6
    s_cbranch_vccnz chk_8_slow
    s_nop 4
    s_branch chk_8_back
chk_9_slow:
    s_add_u32 s100, s100, 1
    s_cmp_gt_u32 s100, 200000
    s_cbranch_scc1 chk_9_back
    s_nop 4
    s_sleep 4
    buffer_load_dwordx2 v[62:63], v60, s[36:39], 0 offen sc1
    s_waitcnt vmcnt(0)
    v_xor_b32 v6, s64, v62
    v_mov_b32 v7, s64
    v_bitop3_b32 v6, v63, v7, v6 bitop3:0xbe
    v_cmp_ne_u32 vcc, 0, v6
    s_cbranch_vccnz chk_9_slow
    s_nop 4
    s_add_u32 m0, s101, 0
    s_nop 0
    buffer_load_dwordx4 v75, s[36:39], s0 offen sc1 lds
    s_add_u32 m0, s101, 1024
    s_nop 0
    buffer_load_dwordx4 v75, s[36:39], s1 offen sc1 lds
    s_add_u32 m0, s101, 2048
    s_nop 0
    buffer_load_dwordx4 v75, s[36:39], s69 offen sc1 lds
    buffer_load_dwordx4 v[68:71], v75, s[36:39], s42 offen sc1
    s_waitcnt vmcnt(0)
    s_branch chk_9_back
chk_35_slow:
    s_add_u32 s100, s100, 1
    s_cmp_gt_u32 s100, 200000
    s_cbranch_scc1 chk_35_back
    s_nop 4
    s_sleep 4
    buffer_load_dwordx2 v[130:131], v2, s[36:39], s96 offen offset:0 sc1
    buffer_load_dwordx2 v[132:133], v2, s[36:39], s96 offen offset:2048 sc1
    buffer_load_dwordx2 v[134:135], v2, s[36:39], s97 offen offset:0 sc1
    buffer_load_dwordx2 v[136:137], v2, s[36:39], s97 offen offset:2048 sc1
    buffer_load_dwordx2 v[138:139], v2, s[36:39], s98 offen offset:0 sc1
    buffer_load_dwordx2 v[140:141], v2, s[36:39], s98 offen offset:2048 sc1
    buffer_load_dwordx2 v[142:143], v2, s[36:39], s99 offen offset:0 sc1
    s_waitcnt vmcnt(0)
    v_xor_b32 v17, s64, v131
    v_mov_b32 v18, s64
    v_bitop3_b32 v17, v133, v18, v17 bitop3:0xbe
    v_bitop3_b32 v17, v135, v18, v17 bitop3:0xbe
    v_bitop3_b32 v17, v137, v18, v17 bitop3:0xbe
    v_bitop3_b32 v17, v139, v18, v17 bitop3:0xbe
    v_bitop3_b32 v17, v141, v18, v17 bitop3:0xbe
    v_bitop3_b32 v17, v143, v18, v17 bitop3:0xbe
    v_cmp_ne_u32 vcc, 0, v17
    s_cbranch_vccnz chk_35_slow
    s_nop 4
    s_branch chk_35_back
chk_36_slow:
    s_add_u32 s100, s100, 1
    s_cmp_gt_u32 s100, 200000
    s_cbranch_scc1 chk_36_back
    s_nop 4
    s_sleep 4
    buffer_load_dwordx4 v[124:127], v128, s[36:39], s68 offen sc1
    s_waitcnt vmcnt(0)
    v_cmp_ne_u32 vcc, s64, v127
    s_cbranch_vccnz chk_36_slow
    s_nop 4
    s_branch chk_36_back
chk_43_slow:
    s_add_u32 s100, s100, 1
    s_cmp_gt_u32 s100, 200000
    s_cbranch_scc1 chk_43_back
    s_nop 4
    s_sleep 4
    buffer_load_dwordx2 v[62:63], v60, s[36:39], 0 offen sc1
    s_waitcnt vmcnt(0)
    v_xor_b32 v6, s64, v62
    v_mov_b32 v7, s64
    v_bitop3_b32 v6, v63, v7, v6 bitop3:0xbe
    v_cmp_ne_u32 vcc, 0, v6
    s_cbranch_vccnz chk_43_slow
    s_nop 4
    s_branch chk_43_back
chk_45_slow:
    s_add_u32 s100, s100, 1
    s_cmp_gt_u32 s100, 200000
    s_cbranch_scc1 chk_45_back
    s_nop 4
    s_sleep 4
    buffer_load_dwordx2 v[66:67], v61, s[36:39], 0 offen sc1
    s_waitcnt vmcnt(0)
    v_xor_b32 v62, s64, v66
    v_mov_b32 v63, s64
    v_bitop3_b32 v62, v67, v63, v62 bitop3:0xbe
    v_cmp_ne_u32 vcc, 0, v62
    s_cbranch_vccnz chk_45_slow
    s_nop 4
    s_add_u32 m0, s101, 24576
    s_add_u32 s82, s0, s41
    buffer_load_dwordx4 v75, s[36:39], s82 offen sc1 lds
    s_add_u32 m0, s101, 25600
    s_add_u32 s82, s1, s41
    buffer_load_dwordx4 v75, s[36:39], s82 offen sc1 lds
    s_add_u32 m0, s101, 26624
    s_add_u32 s82, s69, s41
    buffer_load_dwordx4 v75, s[36:39], s82 offen sc1 lds
    s_waitcnt vmcnt(0)
    s_branch chk_45_back
chk_46_slow0:
    s_mov_b32 s89, vcc_lo
chk_46_slow:
    s_add_u32 s100, s100, 1
    s_cmp_gt_u32 s100, 200000
    s_cbranch_scc1 chk_46_back
    s_nop 4
    s_sleep 4
    buffer_load_dwordx2 v[64:65], v150, s[36:39], 0 offen sc1
    s_waitcnt vmcnt(0)
    v_xor_b32 v60, s64, v64
    v_mov_b32 v61, s64
    v_bitop3_b32 v60, v65, v61, v60 bitop3:0xbe
    v_cmp_ne_u32 vcc, 0, v60
    s_cbranch_vccnz chk_46_slow
    s_nop 4
    s_and_b32 s88, s89, 0x3
    s_cbranch_scc0 chk_46_p0
    s_add_u32 s82, s56, s63
    buffer_load_dwordx4 v[152:155], v75, s[36:39], s82 offen offset:0 sc1
    s_add_u32 s82, s56, s63
    buffer_load_dwordx4 v[156:159], v75, s[36:39], s82 offen offset:1024 sc1
chk_46_p0:
    s_and_b32 s88, s89, 0xc
    s_cbranch_scc0 chk_46_p1
    s_add_u32 s82, s57, s63
    buffer_load_dwordx4 v[160:163], v75, s[36:39], s82 offen offset:0 sc1
    s_add_u32 s82, s57, s63
    buffer_load_dwordx4 v[164:167], v75, s[36:39], s82 offen offset:1024 sc1
chk_46_p1:
    s_and_b32 s88, s89, 0x30
    s_cbranch_scc0 chk_46_p2
    s_add_u32 s82, s58, s63
    buffer_load_dwordx4 v[168:171], v75, s[36:39], s82 offen offset:0 sc1
    s_add_u32 s82, s58, s63
    buffer_load_dwordx4 v[172:175], v75, s[36:39], s82 offen offset:1024 sc1
chk_46_p2:
    s_and_b32 s88, s89, 0xc0
    s_cbranch_scc0 chk_46_p3
    s_add_u32 s82, s59, s63
    buffer_load_dwordx4 v[176:179], v75, s[36:39], s82 offen offset:0 sc1
    s_add_u32 s82, s59, s63
    buffer_load_dwordx4 v[180:183], v75, s[36:39], s82 offen offset:1024 sc1
chk_46_p3:
    s_and_b32 s88, s89, 0x300
    s_cbranch_scc0 chk_46_p4
    s_add_u32 s82, s60, s63
    buffer_load_dwordx4 v[184:187], v75, s[36:39], s82 offen offset:0 sc1
    s_add_u32 s82, s60, s63
    buffer_load_dwordx4 v[188:191], v75, s[36:39], s82 offen offset:1024 sc1
chk_46_p4:
    s_and_b32 s88, s89, 0xc00
    s_cbranch_scc0 chk_46_p5
    s_add_u32 s82, s61, s63
    buffer_load_dwordx4 v[192:195], v75, s[36:39], s82 offen offset:0 sc1
    s_add_u32 s82, s61, s63
    buffer_load_dwordx4 v[196:199], v75, s[36:39], s82 offen offset:1024 sc1
chk_46_p5:
    s_and_b32 s88, s89, 0x3000
    s_cbranch_scc0 chk_46_p6
    s_add_u32 s82, s62, s63
    buffer_load_dwordx4 v[200:203], v75, s[36:39], s82 offen offset:0 sc1
    s_add_u32 s82, s62, s63
    buffer_load_dwordx4 v[204:207], v75, s[36:39], s82 offen offset:1024 sc1
chk_46_p6:
    s_waitcnt vmcnt(0)
    s_branch chk_46_back
chk_47_slow0:
    s_mov_b32 s89, vcc_lo
chk_47_slow:
    s_add_u32 s100, s100, 1
    s_cmp_gt_u32 s100, 200000
    s_cbranch_scc1 chk_47_back
    s_nop 4
    s_sleep 4
    buffer_load_dwordx2 v[58:59], v151, s[36:39], 0 offen sc1
    s_waitcnt vmcnt(0)
    v_xor_b32 v60, s64, v58
    v_mov_b32 v61, s64
    v_bitop3_b32 v60, v59, v61, v60 bitop3:0xbe
    v_cmp_ne_u32 vcc, 0, v60
    s_cbranch_vccnz chk_47_slow
    s_nop 4
    s_and_b32 s88, s89, 0x3
    s_cbranch_scc0 chk_47_p0
    s_add_u32 s82, s56, s63
    buffer_load_dwordx4 v[208:211], v75, s[36:39], s82 offen offset:0 sc1
    s_add_u32 s82, s56, s63
    buffer_load_dwordx4 v[212:215], v75, s[36:39], s82 offen offset:1024 sc1
chk_47_p0:
    s_and_b32 s88, s89, 0xc
    s_cbranch_scc0 chk_47_p1
    s_add_u32 s82, s57, s63
    buffer_load_dwordx4 v[216:219], v75, s[36:39], s82 offen offset:0 sc1
    s_add_u32 s82, s57, s63
    buffer_load_dwordx4 v[220:223], v75, s[36:39], s82 offen offset:1024 sc1
chk_47_p1:
    s_and_b32 s88, s89, 0x30
    s_cbranch_scc0 chk_47_p2
    s_add_u32 s82, s58, s63
    buffer_load_dwordx4 v[224:227], v75, s[36:39], s82 offen offset:0 sc1
    s_add_u32 s82, s58, s63
    buffer_load_dwordx4 v[228:231], v75, s[36:39], s82 offen offset:1024 sc1
chk_47_p2:
    s_and_b32 s88, s89, 0xc0
    s_cbranch_scc0 chk_47_p3
    s_add_u32 s82, s59, s63
    buffer_load_dwordx4 v[232:235], v75, s[36:39], s82 offen offset:0 sc1
    s_add_u32 s82, s59, s63
    buffer_load_dwordx4 v[236:239], v75, s[36:39], s82 offen offset:1024 sc1
chk_47_p3:
    s_and_b32 s88, s89, 0x300
    s_cbranch_scc0 chk_47_p4
    s_add_u32 s82, s60, s63
    buffer_load_dwordx4 v[240:243], v75, s[36:39], s82 offen offset:0 sc1
    s_add_u32 s82, s60, s63
    buffer_load_dwordx4 v[244:247], v75, s[36:39], s82 offen offset:1024 sc1
chk_47_p4:
    s_and_b32 s88, s89, 0xc00
    s_cbranch_scc0 chk_47_p5
    s_add_u32 s82, s61, s63
    buffer_load_dwordx4 v[248:251], v75, s[36:39], s82 offen offset:0 sc1
    s_add_u32 s82, s61, s63
    buffer_load_dwordx4 v[252:255], v75, s[36:39], s82 offen offset:1024 sc1
chk_47_p5:
    s_and_b32 s88, s89, 0x3000
    s_cbranch_scc0 chk_47_p6
    s_add_u32 s82, s62, s63
    buffer_load_dwordx4 v[152:155], v75, s[36:39], s82 offen offset:0 sc1
    s_add_u32 s82, s62, s63
    buffer_load_dwordx4 v[156:159], v75, s[36:39], s82 offen offset:1024 sc1
chk_47_p6:
    s_waitcnt vmcnt(0)
    s_branch chk_47_back
chk_48_slow:
    s_add_u32 s100, s100, 1
    s_cmp_gt_u32 s100, 200000
    s_cbranch_scc1 chk_48_back
    s_nop 4
    s_sleep 4
    s_add_u32 s82, s43, 0
    buffer_load_dwordx4 v[160:163], v75, s[36:39], s82 offen sc1
    s_waitcnt vmcnt(0)
    v_xor_b32 v163, s76, v163
    v_cmp_lt_u32 vcc, 0xffff, v163
    s_cbranch_vccnz chk_48_slow
    s_nop 4
    s_branch chk_48_back
chk_49_slow:
    s_add_u32 s100, s100, 1
    s_cmp_gt_u32 s100, 200000
    s_cbranch_scc1 chk_49_back
    s_nop 4
    s_sleep 4
    s_add_u32 s82, s43, 4096
    buffer_load_dwordx4 v[164:167], v75, s[36:39], s82 offen sc1
    s_waitcnt vmcnt(0)
    v_xor_b32 v167, s76, v167
    v_cmp_lt_u32 vcc, 0xffff, v167
    s_cbranch_vccnz chk_49_slow
    s_nop 4
    s_branch chk_49_back
chk_50_slow:
    s_add_u32 s100, s100, 1
    s_cmp_gt_u32 s100, 200000
    s_cbranch_scc1 chk_50_back
    s_nop 4
    s_sleep 4
    s_add_u32 s82, s43, 8192
    buffer_load_dwordx4 v[168:171], v75, s[36:39], s82 offen sc1
    s_waitcnt vmcnt(0)
    v_xor_b32 v171, s76, v171
    v_cmp_lt_u32 vcc, 0xffff, v171
    s_cbranch_vccnz chk_50_slow
    s_nop 4
    s_branch chk_50_back
chk_51_slow:
    s_add_u32 s100, s100, 1
    s_cmp_gt_u32 s100, 200000
    s_cbranch_scc1 chk_51_back
    s_nop 4
    s_sleep 4
    s_add_u32 s82, s43, 12288
    buffer_load_dwordx4 v[172:175], v75, s[36:39], s82 offen sc1
    s_waitcnt vmcnt(0)
    v_xor_b32 v175, s76, v175
    v_cmp_lt_u32 vcc, 0xffff, v175
    s_cbranch_vccnz chk_51_slow
    s_nop 4
    s_branch chk_51_back
chk_52_slow:
    s_add_u32 s100, s100, 1
    s_cmp_gt_u32 s100, 200000
    s_cbranch_scc1 chk_52_back
    s_nop 4
    s_sleep 4
    s_add_u32 s82, s43, 16384
    buffer_load_dwordx4 v[176:179], v75, s[36:39], s82 offen sc1
    s_waitcnt vmcnt(0)
    v_xor_b32 v179, s76, v179
    v_cmp_lt_u32 vcc, 0xffff, v179
    s_cbranch_vccnz chk_52_slow
    s_nop 4
    s_branch chk_52_back
chk_53_slow:
    s_add_u32 s100, s100, 1
    s_cmp_gt_u32 s100, 200000
    s_cbranch_scc1 chk_53_back
    s_nop 4
    s_sleep 4
    s_add_u32 s82, s43, 20480
    buffer_load_dwordx4 v[180:183], v75, s[36:39], s82 offen sc1
    s_waitcnt vmcnt(0)
    v_xor_b32 v183, s76, v183
    v_cmp_lt_u32 vcc, 0xffff, v183
    s_cbranch_vccnz chk_53_slow
    s_nop 4
    s_branch chk_53_back
chk_54_slow:
    s_add_u32 s100, s100, 1
    s_cmp_gt_u32 s100, 200000
    s_cbranch_scc1 chk_54_back
    s_nop 4
    s_sleep 4
    s_add_u32 s82, s43, 24576
    buffer_load_dwordx4 v[184:187], v75, s[36:39], s82 offen sc1
    s_waitcnt vmcnt(0)
    v_xor_b32 v187, s76, v187
    v_cmp_lt_u32 vcc, 0xffff, v187
    s_cbranch_vccnz chk_54_slow
    s_nop 4
    s_branch chk_54_back
chk_55_slow:
    s_add_u32 s100, s100, 1
    s_cmp_gt_u32 s100, 200000
    s_cbranch_scc1 chk_55_back
    s_nop 4
    s_sleep 4
    s_add_u32 s82, s43, 28672
    buffer_load_dwordx4 v[188:191], v75, s[36:39], s82 offen sc1
    s_waitcnt vmcnt(0)
    v_xor_b32 v191, s76, v191
    v_cmp_lt_u32 vcc, 0xffff, v191
    s_cbranch_vccnz chk_55_slow
    s_nop 4
    s_branch chk_55_back
chk_62_slow:
    s_add_u32 s100, s100, 1
    s_cmp_gt_u32 s100, 200000
    s_cbranch_scc1 chk_62_back
    s_nop 4
    s_sleep 4
    buffer_load_dwordx2 v[4:5], v60, s[36:39], 0 offen offset:0 sc1
    buffer_load_dwordx2 v[6:7], v60, s[36:39], 0 offen offset:32 sc1
    buffer_load_dwordx2 v[8:9], v60, s[36:39], 0 offen offset:64 sc1
    buffer_load_dwordx2 v[10:11], v60, s[36:39], 0 offen offset:96 sc1
    s_waitcnt vmcnt(0)
    v_xor_b32 v62, s64, v4
    v_mov_b32 v63, s64
    v_bitop3_b32 v62, v5, v63, v62 bitop3:0xbe
    v_bitop3_b32 v62, v6, v63, v62 bitop3:0xbe
    v_bitop3_b32 v62, v7, v63, v62 bitop3:0xbe
    v_bitop3_b32 v62, v8, v63, v62 bitop3:0xbe
    v_bitop3_b32 v62, v9, v63, v62 bitop3:0xbe
    v_bitop3_b32 v62, v10, v63, v62 bitop3:0xbe
    v_bitop3_b32 v62, v11, v63, v62 bitop3:0xbe
    v_cmp_ne_u32 vcc, 0, v62
    s_cbranch_vccnz chk_62_slow
    s_nop 4
    s_branch chk_62_back

.p2align 8
.fill 256, 4, 0xbf810000
L_codeend:
.section .rodata,"a"
.p2align 6
.amdhsa_kernel recurrent_scan__sliding_block__geglu_ffn__prompt_kernel
  .amdhsa_next_free_vgpr 256
  .amdhsa_next_free_sgpr 102
  .amdhsa_accum_offset 256
  .amdhsa_group_segment_fixed_size 0
  .amdhsa_kernarg_size 80
  .amdhsa_user_sgpr_count 2
  .amdhsa_user_sgpr_kernarg_segment_ptr 1
  .amdhsa_system_sgpr_workgroup_id_x 1
.end_amdhsa_kernel
```
